```python
import torch

def _softmax(x, axis=-1):
    return torch.softmax(x, dim=axis)
def _gelu(x):
    return torch.nn.functional.gelu(x, approximate="tanh")
def _silu(x):
    return torch.nn.functional.silu(x)
def _sigmoid(x):
    return torch.sigmoid(x)
def _layernorm(x, axis=-1, eps=1e-5):
    m = x.mean(dim=axis, keepdim=True)
    v = x.var(dim=axis, keepdim=True, unbiased=False)
    return (x - m) / torch.sqrt(v + eps)
def _scatter_add(tgt, idx, src, axis=0):
    return tgt.clone().index_add_(axis, idx, src)
def _segment_sum(src, seg, n):
    out = torch.zeros((n,) + src.shape[1:], dtype=src.dtype)
    return out.index_add_(0, seg, src)
def _pad(x, pw):
    flat = tuple(v for pair in reversed(pw) for v in pair)
    return torch.nn.functional.pad(x, flat)

kernel_name = 'interleave_layers__sliding_block__mixer_channel_mlp__prompt'

def setup_inputs():

    _w = (lambda a: (lambda t: t.to(torch.bfloat16) if t.is_floating_point() else t)(torch.as_tensor(a)))
    def _A_setup():
        B, S, D = 1, 2048, 512
        return {
            "x": _w((lambda *s: torch.randn(*s, dtype=torch.bfloat16) * 0.05)(B, S, D)),
            "wqkv": _w((lambda *s: torch.randn(*s, dtype=torch.bfloat16) * 0.05)(D, 3 * D)),
            "wo": _w((lambda *s: torch.randn(*s, dtype=torch.bfloat16) * 0.05)(D, D)),
        }
    _A_in = _A_setup()

    def _B_setup():
        B, S, D, F = 1, 2048, 512, 1376
        return {
            "x": _w((lambda *s: torch.randn(*s, dtype=torch.bfloat16) * 0.05)(B, S, D)),
            "w1": _w((lambda *s: torch.randn(*s, dtype=torch.bfloat16) * 3.2)(D, F) * (D ** -0.5)),
            "b1": _w((lambda *s: torch.randn(*s, dtype=torch.bfloat16) * 0.8)(F)),
            "w2": _w((lambda *s: torch.randn(*s, dtype=torch.bfloat16) * 0.2)(F, D) * (F ** -0.5)),
            "b2": _w((lambda *s: torch.randn(*s, dtype=torch.bfloat16) * 0.2)(D)),
        }
    _B_in = _B_setup()

    return {
        "A_x": _A_in["x"],
        "A_wqkv": _A_in["wqkv"],
        "A_wo": _A_in["wo"],
        "B_x": _B_in["x"],
        "B_w1": _B_in["w1"],
        "B_b1": _B_in["b1"],
        "B_w2": _B_in["w2"],
        "B_b2": _B_in["b2"],
    }

def reference(A_x, A_wqkv, A_wo, B_x, B_w1, B_b1, B_w2, B_b2):
    def _A_ref(x, wqkv, wo):
        B, S, D = x.shape
        H = 32; Dh = D // H; W = 256
        qkv = (lambda x, *d: x.permute(*d))((x @ wqkv).reshape(B, S, 3, H, Dh), 2, 0, 3, 1, 4)
        q, k, v = qkv[0], qkv[1], qkv[2]
        scores = torch.einsum("bhqd,bhkd->bhqk", q, k) * (Dh ** -0.5)
        idx = torch.arange(S)
        mask = (idx[:, None] - idx[None, :] >= 0) & (idx[:, None] - idx[None, :] < W)
        scores = torch.where(mask[None, None], scores, -1e9)
        p = _softmax(scores, axis=-1)
        o = torch.einsum("bhqk,bhkd->bhqd", p, v)
        return (lambda x, *d: x.permute(*d))(o, 0, 2, 1, 3).reshape(B, S, D) @ wo

    def _B_ref(x, w1, b1, w2, b2):
        y = _layernorm(x, axis=-1)
        h = _gelu(torch.einsum("bsd,df->bsf", y, w1) + b1)
        return torch.einsum("bsf,fd->bsd", h, w2) + b2

    x = A_x
    x = x + _A_ref(_layernorm(x, axis=-1), A_wqkv, A_wo)
    x = x + _B_ref(_layernorm(x, axis=-1), B_w1, B_b1, B_w2, B_b2)
    x = x + _A_ref(_layernorm(x, axis=-1), A_wqkv, A_wo)
    x = x + _B_ref(_layernorm(x, axis=-1), B_w1, B_b1, B_w2, B_b2)
    return x
```

```asm
; @launch grid=(256,1,1) block=(512,1,1) lds=163840
.amdgcn_target "amdgcn-amd-amdhsa--gfx950"
.text
.globl interleave_layers__sliding_block__mixer_channel_mlp__prompt_kernel
.p2align 8
.type interleave_layers__sliding_block__mixer_channel_mlp__prompt_kernel,@function
interleave_layers__sliding_block__mixer_channel_mlp__prompt_kernel:
    s_cmp_ge_u32 s2, 256
    s_cbranch_scc1 L_exit
    s_load_dwordx16 s[64:79], s[0:1], 0
    s_getpc_b64 s[94:95]
L_pf_pc3:
    s_mov_b32 m0, 163072
    v_lshlrev_b32 v2, 7, v0
    v_min_u32 v2, L_exit-L_pf_pc3, v2
    global_load_lds_dword v2, s[94:95]
    s_load_dwordx4 s[88:91], s[0:1], 64
    s_load_dwordx2 s[92:93], s[0:1], 80
    v_lshrrev_b32 v1, 6, v0
    v_and_b32 v0, 63, v0
    s_and_b32 s49, s2, 7
    v_readfirstlane_b32 s38, v1
    s_lshr_b32 s50, s2, 3
    s_lshr_b32 s51, s50, 3
    s_lshl_b32 s49, s49, 2
    s_add_u32 s36, s49, s51
    s_and_b32 s37, s50, 7
    s_and_b32 s39, s38, 3
    s_lshl_b32 s48, s39, 10
    s_mov_b32 s40, 0
    s_mov_b32 s85, 0
    s_mov_b32 s41, 0
    v_lshlrev_b32 v1, 4, v0
    v_mov_b32 v15, 0
    s_waitcnt lgkmcnt(0)
    s_mov_b32 s4, s64
    s_and_b32 s5, s65, 0xffff
    s_mov_b32 s6, 2097152
    s_mov_b32 s7, 0x20000
    s_mov_b32 s8, s66
    s_and_b32 s9, s67, 0xffff
    s_mov_b32 s10, 1572864
    s_mov_b32 s11, 0x20000
    s_mov_b32 s12, s68
    s_and_b32 s13, s69, 0xffff
    s_mov_b32 s14, 524288
    s_mov_b32 s15, 0x20000
    s_mov_b32 s16, s72
    s_and_b32 s17, s73, 0xffff
    s_mov_b32 s18, 1409024
    s_mov_b32 s19, 0x20000
    s_mov_b32 s20, s76
    s_and_b32 s21, s77, 0xffff
    s_mov_b32 s22, 1409024
    s_mov_b32 s23, 0x20000
    s_mov_b32 s24, s92
    s_and_b32 s25, s93, 0xffff
    s_mov_b32 s26, 33554432
    s_mov_b32 s27, 0x20000
    s_mov_b32 s28, s88
    s_and_b32 s29, s89, 0xffff
    s_mov_b32 s30, 2097152
    s_mov_b32 s31, 0x20000
    s_mov_b32 s32, s90
    s_and_b32 s33, s91, 0xffff
    s_mov_b32 s34, 256
    s_mov_b32 s35, 0x20000
    s_mov_b32 s52, 32505856
    s_buffer_load_dword s87, s[24:27], s52
    s_mov_b32 s94, s74
    s_mov_b32 s95, s75
    s_mov_b32 s96, s78
    s_mov_b32 s97, s79
    s_mul_i32 s98, s37, 10
    s_add_u32 s98, s98, 6
    s_mul_i32 s99, s37, 12
    s_cmp_lt_u32 s37, 3
    s_cselect_b32 s98, s99, s98
    s_cselect_b32 s99, 12, 10
    s_mov_b32 s68, 0x0000ffff
    s_mov_b32 s69, 0x0000ffff
    s_mov_b64 s[78:79], 0xffff
    s_mov_b32 s80, 1
    s_mov_b32 s81, 1
    s_lshl_b32 s59, s36, 13
    s_add_u32 s59, s59, 65536
    s_cmp_ge_u32 s38, 4
    s_cbranch_scc1 L_loader
    s_lshr_b32 s42, s38, 1
    s_and_b32 s43, s38, 1
    s_cmp_lg_u32 s38, 0
    s_cbranch_scc1 L_c_xt
    v_lshlrev_b32 v88, 7, v0
    s_lshl_b32 s50, s36, 16
    s_lshl_b32 s51, s37, 13
    s_add_u32 s50, s50, s51
    s_mov_b32 m0, 163072
    s_add_u32 s52, s50, 0
    buffer_load_dword v88, s[4:7], s52 offen lds
L_c_xt:
    s_lshl_b32 s49, s36, 16
    s_lshl_b32 s50, s42, 15
    s_add_u32 s49, s49, s50
    s_lshl_b32 s50, s37, 7
    s_add_u32 s49, s49, s50
    s_lshl_b32 s50, s43, 6
    s_add_u32 s75, s49, s50
    s_cmp_lt_u32 s38, 2
    s_cbranch_scc1 L_c_nob
    s_cmp_eq_u32 s38, 2
    s_cselect_b32 s49, s94, s96
    s_cselect_b32 s50, s95, s97
    s_mov_b32 s44, s49
    s_and_b32 s45, s50, 0xffff
    s_movk_i32 s51, 1024
    s_cmp_eq_u32 s38, 2
    s_cselect_b32 s46, 2752, s51
    s_mov_b32 s47, 0x20000
    s_cmp_eq_u32 s38, 2
    s_lshl_b32 s49, s98, 5
    s_lshl_b32 s50, s37, 7
    s_cmp_eq_u32 s38, 2
    s_cselect_b32 s49, s49, s50
    s_mov_b32 s50, 160000
    s_cselect_b32 s50, 159232, s50
    s_cselect_b32 s51, 48, 16
    v_lshlrev_b32 v90, 3, v0
    buffer_load_dwordx2 v[240:241], v90, s[44:47], s49 offen
    v_add_u32 v242, s50, v1
    s_mov_b32 s101, s51
L_c_nob:
    s_lshl_b32 s49, s43, 10
    v_add_u32 v2, s49, v1
    v_add_u32 v3, 0x10000, v2
    v_add_u32 v4, 0x20000, v2
    s_mul_i32 s49, s43, 3072
    v_add_u32 v5, s49, v1
    s_lshl_b32 s49, s43, 10
    s_add_u32 s49, s49, 1024
    v_add_u32 v8, s49, v1
    v_add_u32 v6, 0x10000, v5
    v_add_u32 v7, 0x20000, v5
    v_add_u32 v9, 0x10000, v8
    v_add_u32 v10, 0x20000, v8
    s_lshl_b32 s49, s42, 10
    v_add_u32 v11, s49, v1
    v_lshrrev_b32 v88, 5, v0
    v_lshlrev_b32 v88, 4, v88
    s_lshl_b32 s49, s43, 7
    v_add_u32 v12, s49, v88
    s_lshl_b32 s49, s42, 7
    v_add_u32 v14, s49, v88
    v_and_b32 v88, 31, v0
    v_lshlrev_b32 v88, 2, v88
    v_add_u32 v13, s49, v88
    s_lshl_b32 s53, s36, 16
    s_lshl_b32 s49, s42, 15
    s_add_u32 s53, s53, s49
    s_lshl_b32 s49, s37, 12
    s_add_u32 s53, s53, s49
    s_lshl_b32 s49, s43, 11
    s_add_u32 s53, s53, s49
    s_add_u32 s53, s53, 1048576
    s_mul_i32 s54, s36, 180224
    s_add_u32 s54, s54, 3145728
    s_lshl_b32 s58, s36, 3
    s_add_u32 s58, s58, s37
    s_lshl_b32 s58, s58, 14
    s_lshl_b32 s49, s42, 12
    s_add_u32 s58, s58, s49
    s_lshl_b32 s49, s43, 11
    s_add_u32 s58, s58, s49
    s_add_u32 s58, s58, 9437184
    s_lshl_b32 s49, s43, 1
    s_add_u32 s49, s49, 0
    s_add_u32 s50, s49, s98
    s_lshl_b32 s50, s50, 10
    s_mul_i32 s51, s42, 88064
    s_add_u32 s50, s50, s51
    s_add_u32 s50, s50, s54
    s_cmp_lt_u32 s49, s99
    s_cselect_b32 s61, s50, 0x7ffff000
    s_lshl_b32 s49, s43, 1
    s_add_u32 s49, s49, 1
    s_add_u32 s50, s49, s98
    s_lshl_b32 s50, s50, 10
    s_mul_i32 s51, s42, 88064
    s_add_u32 s50, s50, s51
    s_add_u32 s50, s50, s54
    s_cmp_lt_u32 s49, s99
    s_cselect_b32 s62, s50, 0x7ffff000
    s_lshl_b32 s49, s43, 1
    s_add_u32 s49, s49, 4
    s_add_u32 s50, s49, s98
    s_lshl_b32 s50, s50, 10
    s_mul_i32 s51, s42, 88064
    s_add_u32 s50, s50, s51
    s_add_u32 s50, s50, s54
    s_cmp_lt_u32 s49, s99
    s_cselect_b32 s63, s50, 0x7ffff000
    s_lshl_b32 s49, s43, 1
    s_add_u32 s49, s49, 5
    s_add_u32 s50, s49, s98
    s_lshl_b32 s50, s50, 10
    s_mul_i32 s51, s42, 88064
    s_add_u32 s50, s50, s51
    s_add_u32 s50, s50, s54
    s_cmp_lt_u32 s49, s99
    s_cselect_b32 s64, s50, 0x7ffff000
    s_lshl_b32 s49, s43, 1
    s_add_u32 s49, s49, 8
    s_add_u32 s50, s49, s98
    s_lshl_b32 s50, s50, 10
    s_mul_i32 s51, s42, 88064
    s_add_u32 s50, s50, s51
    s_add_u32 s50, s50, s54
    s_cmp_lt_u32 s49, s99
    s_cselect_b32 s65, s50, 0x7ffff000
    s_lshl_b32 s49, s43, 1
    s_add_u32 s49, s49, 9
    s_add_u32 s50, s49, s98
    s_lshl_b32 s50, s50, 10
    s_mul_i32 s51, s42, 88064
    s_add_u32 s50, s50, s51
    s_add_u32 s50, s50, s54
    s_cmp_lt_u32 s49, s99
    s_cselect_b32 s66, s50, 0x7ffff000
    s_mov_b32 s82, 989855744
    s_mov_b32 s83, 925353388
    s_mov_b32 s84, 1052289595
    s_lshl_b32 s50, s38, 14
    s_lshl_b32 s51, s36, 16
    s_add_u32 s51, s51, s50
    v_xor_b32 v88, 0, v1
    s_add_u32 m0, s50, 0
    s_add_u32 s49, s51, 0
    buffer_load_dwordx4 v88, s[4:7], s49 offen lds
    v_xor_b32 v88, 16, v1
    s_add_u32 m0, s50, 1024
    s_add_u32 s49, s51, 1024
    buffer_load_dwordx4 v88, s[4:7], s49 offen lds
    v_xor_b32 v88, 32, v1
    s_add_u32 m0, s50, 2048
    s_add_u32 s49, s51, 2048
    buffer_load_dwordx4 v88, s[4:7], s49 offen lds
    v_xor_b32 v88, 48, v1
    s_add_u32 m0, s50, 3072
    s_add_u32 s49, s51, 3072
    buffer_load_dwordx4 v88, s[4:7], s49 offen lds
    v_xor_b32 v88, 64, v1
    s_add_u32 m0, s50, 4096
    s_add_u32 s49, s51, 4096
    buffer_load_dwordx4 v88, s[4:7], s49 offen lds
    v_xor_b32 v88, 80, v1
    s_add_u32 m0, s50, 5120
    s_add_u32 s49, s51, 5120
    buffer_load_dwordx4 v88, s[4:7], s49 offen lds
    v_xor_b32 v88, 96, v1
    s_add_u32 m0, s50, 6144
    s_add_u32 s49, s51, 6144
    buffer_load_dwordx4 v88, s[4:7], s49 offen lds
    v_xor_b32 v88, 112, v1
    s_add_u32 m0, s50, 7168
    s_add_u32 s49, s51, 7168
    buffer_load_dwordx4 v88, s[4:7], s49 offen lds
    v_xor_b32 v88, 128, v1
    s_add_u32 m0, s50, 8192
    s_add_u32 s49, s51, 8192
    buffer_load_dwordx4 v88, s[4:7], s49 offen lds
    v_xor_b32 v88, 144, v1
    s_add_u32 m0, s50, 9216
    s_add_u32 s49, s51, 9216
    buffer_load_dwordx4 v88, s[4:7], s49 offen lds
    v_xor_b32 v88, 160, v1
    s_add_u32 m0, s50, 10240
    s_add_u32 s49, s51, 10240
    buffer_load_dwordx4 v88, s[4:7], s49 offen lds
    v_xor_b32 v88, 176, v1
    s_add_u32 m0, s50, 11264
    s_add_u32 s49, s51, 11264
    buffer_load_dwordx4 v88, s[4:7], s49 offen lds
    v_xor_b32 v88, 192, v1
    s_add_u32 m0, s50, 12288
    s_add_u32 s49, s51, 12288
    buffer_load_dwordx4 v88, s[4:7], s49 offen lds
    v_xor_b32 v88, 208, v1
    s_add_u32 m0, s50, 13312
    s_add_u32 s49, s51, 13312
    buffer_load_dwordx4 v88, s[4:7], s49 offen lds
    v_xor_b32 v88, 224, v1
    s_add_u32 m0, s50, 14336
    s_add_u32 s49, s51, 14336
    buffer_load_dwordx4 v88, s[4:7], s49 offen lds
    v_xor_b32 v88, 240, v1
    s_add_u32 m0, s50, 15360
    s_add_u32 s49, s51, 15360
    buffer_load_dwordx4 v88, s[4:7], s49 offen lds
    v_and_b32 v84, 31, v0
    s_lshl_b32 s50, s42, 5
    v_add_u32 v85, s50, v84
    v_lshlrev_b32 v85, 10, v85
    v_lshrrev_b32 v86, 5, v0
    v_lshl_add_u32 v85, v86, 3, v85
    v_and_b32 v84, 15, v0
    v_lshl_add_u32 v85, v84, 4, v85
    v_and_b32 v96, 15, v0
    s_lshl_b32 s50, s37, 3
    s_lshl_b32 s51, s43, 2
    s_add_u32 s50, s50, s51
    v_and_b32 v97, 31, v0
    s_lshl_b32 s51, s42, 5
    v_add_u32 v97, s51, v97
    v_lshlrev_b32 v97, 10, v97
    v_lshrrev_b32 v98, 5, v0
    v_lshl_add_u32 v97, v98, 3, v97
    s_add_u32 s51, s50, 0
    v_xor_b32 v98, s51, v96
    v_lshl_add_u32 v100, v98, 4, v97
    s_add_u32 s51, s50, 1
    v_xor_b32 v98, s51, v96
    v_lshl_add_u32 v101, v98, 4, v97
    s_add_u32 s51, s50, 2
    v_xor_b32 v98, s51, v96
    v_lshl_add_u32 v102, v98, 4, v97
    s_add_u32 s51, s50, 3
    v_xor_b32 v98, s51, v96
    v_lshl_add_u32 v103, v98, 4, v97
    s_waitcnt lgkmcnt(0)
    s_add_u32 s87, s87, 16
    s_barrier
    s_waitcnt vmcnt(0)
    v_mov_b32 v104, 162820
    v_mov_b32 v105, 1
    s_mov_b64 exec, 1
    ds_add_u32 v104, v105
    s_mov_b64 exec, -1
    s_mov_b32 s60, 400000
L_p1a_meet:
    ds_read_b32 v105, v104
    s_waitcnt lgkmcnt(0)
    v_cmp_gt_u32 vcc, 4, v105
    s_sub_u32 s60, s60, 1
    s_cbranch_scc1 L_p1a_met
    s_cbranch_vccnz L_p1a_meet
L_p1a_met:
    s_cmp_lt_u32 s38, 2
    s_cbranch_scc1 L_c_nob2
    v_cmp_gt_u32 vcc, s101, v0
    v_lshlrev_b32 v244, 16, v240
    v_and_b32 v245, 0xffff0000, v240
    v_lshlrev_b32 v246, 16, v241
    v_and_b32 v247, 0xffff0000, v241
    s_and_saveexec_b64 s[70:71], vcc
    ds_write_b128 v242, v[244:247]
    s_mov_b64 exec, s[70:71]
L_c_nob2:
    ds_read_b64 v[32:33], v100
    ds_read_b64 v[34:35], v101
    ds_read_b64 v[36:37], v102
    ds_read_b64 v[38:39], v103
    s_waitcnt lgkmcnt(0)
    v_lshlrev_b32 v16, 16, v32
    v_and_b32 v17, 0xffff0000, v32
    v_lshlrev_b32 v18, 16, v33
    v_and_b32 v19, 0xffff0000, v33
    v_lshlrev_b32 v20, 16, v34
    v_and_b32 v21, 0xffff0000, v34
    v_lshlrev_b32 v22, 16, v35
    v_and_b32 v23, 0xffff0000, v35
    v_lshlrev_b32 v24, 16, v36
    v_and_b32 v25, 0xffff0000, v36
    v_lshlrev_b32 v26, 16, v37
    v_and_b32 v27, 0xffff0000, v37
    v_lshlrev_b32 v28, 16, v38
    v_and_b32 v29, 0xffff0000, v38
    v_lshlrev_b32 v30, 16, v39
    v_and_b32 v31, 0xffff0000, v39
    v_xor_b32 v48, 0, v85
    v_xor_b32 v49, 16, v85
    v_xor_b32 v50, 32, v85
    v_xor_b32 v51, 48, v85
    v_xor_b32 v52, 64, v85
    v_xor_b32 v53, 80, v85
    v_xor_b32 v54, 96, v85
    v_xor_b32 v55, 112, v85
    v_xor_b32 v56, 128, v85
    v_xor_b32 v57, 144, v85
    v_xor_b32 v58, 160, v85
    v_xor_b32 v59, 176, v85
    v_xor_b32 v60, 192, v85
    v_xor_b32 v61, 208, v85
    v_xor_b32 v62, 224, v85
    v_xor_b32 v63, 240, v85
    v_mov_b32 v80, 0
    v_mov_b32 v81, 0
    v_mov_b32 v82, 0x3f803f80
    ds_read_b64 v[128:129], v48 offset:0
    ds_read_b64 v[130:131], v49 offset:0
    ds_read_b64 v[132:133], v50 offset:0
    ds_read_b64 v[134:135], v51 offset:0
    ds_read_b64 v[136:137], v52 offset:0
    ds_read_b64 v[138:139], v53 offset:0
    ds_read_b64 v[140:141], v54 offset:0
    ds_read_b64 v[142:143], v55 offset:0
    ds_read_b64 v[144:145], v56 offset:0
    ds_read_b64 v[146:147], v57 offset:0
    ds_read_b64 v[148:149], v58 offset:0
    ds_read_b64 v[150:151], v59 offset:0
    ds_read_b64 v[152:153], v60 offset:0
    s_waitcnt lgkmcnt(12)
    ds_read_b64 v[154:155], v61 offset:0
    s_waitcnt lgkmcnt(12)
    ds_read_b64 v[156:157], v62 offset:0
    s_waitcnt lgkmcnt(12)
    ds_read_b64 v[158:159], v63 offset:0
    s_waitcnt lgkmcnt(12)
    ds_read_b64 v[160:161], v48 offset:256
    s_waitcnt lgkmcnt(12)
    ds_read_b64 v[162:163], v49 offset:256
    s_waitcnt lgkmcnt(12)
    ds_read_b64 v[164:165], v50 offset:256
    s_waitcnt lgkmcnt(12)
    ds_read_b64 v[166:167], v51 offset:256
    s_waitcnt lgkmcnt(12)
    ds_read_b64 v[168:169], v52 offset:256
    s_waitcnt lgkmcnt(12)
    ds_read_b64 v[170:171], v53 offset:256
    s_waitcnt lgkmcnt(12)
    ds_read_b64 v[172:173], v54 offset:256
    s_waitcnt lgkmcnt(12)
    ds_read_b64 v[174:175], v55 offset:256
    s_waitcnt lgkmcnt(12)
    ds_read_b64 v[176:177], v56 offset:256
    s_waitcnt lgkmcnt(12)
    ds_read_b64 v[178:179], v57 offset:256
    s_waitcnt lgkmcnt(12)
    ds_read_b64 v[180:181], v58 offset:256
    s_waitcnt lgkmcnt(12)
    ds_read_b64 v[182:183], v59 offset:256
    s_waitcnt lgkmcnt(12)
    ds_read_b64 v[184:185], v60 offset:256
    s_waitcnt lgkmcnt(12)
    ds_read_b64 v[186:187], v61 offset:256
    s_waitcnt lgkmcnt(12)
    ds_read_b64 v[188:189], v62 offset:256
    s_waitcnt lgkmcnt(12)
    ds_read_b64 v[190:191], v63 offset:256
    s_waitcnt lgkmcnt(12)
    ds_read_b64 v[192:193], v48 offset:512
    s_waitcnt lgkmcnt(12)
    ds_read_b64 v[194:195], v49 offset:512
    s_waitcnt lgkmcnt(12)
    ds_read_b64 v[196:197], v50 offset:512
    s_waitcnt lgkmcnt(12)
    ds_read_b64 v[198:199], v51 offset:512
    s_waitcnt lgkmcnt(12)
    ds_read_b64 v[200:201], v52 offset:512
    s_waitcnt lgkmcnt(12)
    ds_read_b64 v[202:203], v53 offset:512
    s_waitcnt lgkmcnt(12)
    ds_read_b64 v[204:205], v54 offset:512
    s_waitcnt lgkmcnt(12)
    ds_read_b64 v[206:207], v55 offset:512
    s_waitcnt lgkmcnt(12)
    ds_read_b64 v[208:209], v56 offset:512
    s_waitcnt lgkmcnt(12)
    ds_read_b64 v[210:211], v57 offset:512
    s_waitcnt lgkmcnt(12)
    ds_read_b64 v[212:213], v58 offset:512
    s_waitcnt lgkmcnt(12)
    ds_read_b64 v[214:215], v59 offset:512
    s_waitcnt lgkmcnt(12)
    ds_read_b64 v[216:217], v60 offset:512
    s_waitcnt lgkmcnt(12)
    ds_read_b64 v[218:219], v61 offset:512
    s_waitcnt lgkmcnt(12)
    ds_read_b64 v[220:221], v62 offset:512
    s_waitcnt lgkmcnt(12)
    ds_read_b64 v[222:223], v63 offset:512
    s_waitcnt lgkmcnt(12)
    ds_read_b64 v[224:225], v48 offset:768
    s_waitcnt lgkmcnt(12)
    ds_read_b64 v[226:227], v49 offset:768
    s_waitcnt lgkmcnt(12)
    ds_read_b64 v[228:229], v50 offset:768
    s_waitcnt lgkmcnt(12)
    ds_read_b64 v[230:231], v51 offset:768
    s_waitcnt lgkmcnt(12)
    ds_read_b64 v[232:233], v52 offset:768
    s_waitcnt lgkmcnt(12)
    ds_read_b64 v[234:235], v53 offset:768
    s_waitcnt lgkmcnt(12)
    ds_read_b64 v[236:237], v54 offset:768
    s_waitcnt lgkmcnt(12)
    ds_read_b64 v[238:239], v55 offset:768
    s_waitcnt lgkmcnt(12)
    ds_read_b64 v[240:241], v56 offset:768
    s_waitcnt lgkmcnt(12)
    ds_read_b64 v[242:243], v57 offset:768
    s_waitcnt lgkmcnt(12)
    ds_read_b64 v[244:245], v58 offset:768
    s_waitcnt lgkmcnt(12)
    ds_read_b64 v[246:247], v59 offset:768
    s_waitcnt lgkmcnt(12)
    ds_read_b64 v[248:249], v60 offset:768
    s_waitcnt lgkmcnt(12)
    ds_read_b64 v[250:251], v61 offset:768
    s_waitcnt lgkmcnt(12)
    ds_read_b64 v[252:253], v62 offset:768
    s_waitcnt lgkmcnt(12)
    ds_read_b64 v[254:255], v63 offset:768
    s_waitcnt lgkmcnt(12)
    s_waitcnt lgkmcnt(0)
    s_cmp_eq_u32 s43, 0
    s_cbranch_scc0 L_p1a_odd
    v_dot2c_f32_bf16 v80, v128, v82
    v_dot2c_f32_bf16 v81, v128, v128
    v_dot2c_f32_bf16 v80, v129, v82
    v_dot2c_f32_bf16 v81, v129, v129
    v_dot2c_f32_bf16 v80, v130, v82
    v_dot2c_f32_bf16 v81, v130, v130
    v_dot2c_f32_bf16 v80, v131, v82
    v_dot2c_f32_bf16 v81, v131, v131
    v_dot2c_f32_bf16 v80, v136, v82
    v_dot2c_f32_bf16 v81, v136, v136
    v_dot2c_f32_bf16 v80, v137, v82
    v_dot2c_f32_bf16 v81, v137, v137
    v_dot2c_f32_bf16 v80, v138, v82
    v_dot2c_f32_bf16 v81, v138, v138
    v_dot2c_f32_bf16 v80, v139, v82
    v_dot2c_f32_bf16 v81, v139, v139
    v_dot2c_f32_bf16 v80, v144, v82
    v_dot2c_f32_bf16 v81, v144, v144
    v_dot2c_f32_bf16 v80, v145, v82
    v_dot2c_f32_bf16 v81, v145, v145
    v_dot2c_f32_bf16 v80, v146, v82
    v_dot2c_f32_bf16 v81, v146, v146
    v_dot2c_f32_bf16 v80, v147, v82
    v_dot2c_f32_bf16 v81, v147, v147
    v_dot2c_f32_bf16 v80, v152, v82
    v_dot2c_f32_bf16 v81, v152, v152
    v_dot2c_f32_bf16 v80, v153, v82
    v_dot2c_f32_bf16 v81, v153, v153
    v_dot2c_f32_bf16 v80, v154, v82
    v_dot2c_f32_bf16 v81, v154, v154
    v_dot2c_f32_bf16 v80, v155, v82
    v_dot2c_f32_bf16 v81, v155, v155
    v_dot2c_f32_bf16 v80, v160, v82
    v_dot2c_f32_bf16 v81, v160, v160
    v_dot2c_f32_bf16 v80, v161, v82
    v_dot2c_f32_bf16 v81, v161, v161
    v_dot2c_f32_bf16 v80, v162, v82
    v_dot2c_f32_bf16 v81, v162, v162
    v_dot2c_f32_bf16 v80, v163, v82
    v_dot2c_f32_bf16 v81, v163, v163
    v_dot2c_f32_bf16 v80, v168, v82
    v_dot2c_f32_bf16 v81, v168, v168
    v_dot2c_f32_bf16 v80, v169, v82
    v_dot2c_f32_bf16 v81, v169, v169
    v_dot2c_f32_bf16 v80, v170, v82
    v_dot2c_f32_bf16 v81, v170, v170
    v_dot2c_f32_bf16 v80, v171, v82
    v_dot2c_f32_bf16 v81, v171, v171
    v_dot2c_f32_bf16 v80, v176, v82
    v_dot2c_f32_bf16 v81, v176, v176
    v_dot2c_f32_bf16 v80, v177, v82
    v_dot2c_f32_bf16 v81, v177, v177
    v_dot2c_f32_bf16 v80, v178, v82
    v_dot2c_f32_bf16 v81, v178, v178
    v_dot2c_f32_bf16 v80, v179, v82
    v_dot2c_f32_bf16 v81, v179, v179
    v_dot2c_f32_bf16 v80, v184, v82
    v_dot2c_f32_bf16 v81, v184, v184
    v_dot2c_f32_bf16 v80, v185, v82
    v_dot2c_f32_bf16 v81, v185, v185
    v_dot2c_f32_bf16 v80, v186, v82
    v_dot2c_f32_bf16 v81, v186, v186
    v_dot2c_f32_bf16 v80, v187, v82
    v_dot2c_f32_bf16 v81, v187, v187
    v_dot2c_f32_bf16 v80, v192, v82
    v_dot2c_f32_bf16 v81, v192, v192
    v_dot2c_f32_bf16 v80, v193, v82
    v_dot2c_f32_bf16 v81, v193, v193
    v_dot2c_f32_bf16 v80, v194, v82
    v_dot2c_f32_bf16 v81, v194, v194
    v_dot2c_f32_bf16 v80, v195, v82
    v_dot2c_f32_bf16 v81, v195, v195
    v_dot2c_f32_bf16 v80, v200, v82
    v_dot2c_f32_bf16 v81, v200, v200
    v_dot2c_f32_bf16 v80, v201, v82
    v_dot2c_f32_bf16 v81, v201, v201
    v_dot2c_f32_bf16 v80, v202, v82
    v_dot2c_f32_bf16 v81, v202, v202
    v_dot2c_f32_bf16 v80, v203, v82
    v_dot2c_f32_bf16 v81, v203, v203
    v_dot2c_f32_bf16 v80, v208, v82
    v_dot2c_f32_bf16 v81, v208, v208
    v_dot2c_f32_bf16 v80, v209, v82
    v_dot2c_f32_bf16 v81, v209, v209
    v_dot2c_f32_bf16 v80, v210, v82
    v_dot2c_f32_bf16 v81, v210, v210
    v_dot2c_f32_bf16 v80, v211, v82
    v_dot2c_f32_bf16 v81, v211, v211
    v_dot2c_f32_bf16 v80, v216, v82
    v_dot2c_f32_bf16 v81, v216, v216
    v_dot2c_f32_bf16 v80, v217, v82
    v_dot2c_f32_bf16 v81, v217, v217
    v_dot2c_f32_bf16 v80, v218, v82
    v_dot2c_f32_bf16 v81, v218, v218
    v_dot2c_f32_bf16 v80, v219, v82
    v_dot2c_f32_bf16 v81, v219, v219
    v_dot2c_f32_bf16 v80, v224, v82
    v_dot2c_f32_bf16 v81, v224, v224
    v_dot2c_f32_bf16 v80, v225, v82
    v_dot2c_f32_bf16 v81, v225, v225
    v_dot2c_f32_bf16 v80, v226, v82
    v_dot2c_f32_bf16 v81, v226, v226
    v_dot2c_f32_bf16 v80, v227, v82
    v_dot2c_f32_bf16 v81, v227, v227
    v_dot2c_f32_bf16 v80, v232, v82
    v_dot2c_f32_bf16 v81, v232, v232
    v_dot2c_f32_bf16 v80, v233, v82
    v_dot2c_f32_bf16 v81, v233, v233
    v_dot2c_f32_bf16 v80, v234, v82
    v_dot2c_f32_bf16 v81, v234, v234
    v_dot2c_f32_bf16 v80, v235, v82
    v_dot2c_f32_bf16 v81, v235, v235
    v_dot2c_f32_bf16 v80, v240, v82
    v_dot2c_f32_bf16 v81, v240, v240
    v_dot2c_f32_bf16 v80, v241, v82
    v_dot2c_f32_bf16 v81, v241, v241
    v_dot2c_f32_bf16 v80, v242, v82
    v_dot2c_f32_bf16 v81, v242, v242
    v_dot2c_f32_bf16 v80, v243, v82
    v_dot2c_f32_bf16 v81, v243, v243
    v_dot2c_f32_bf16 v80, v248, v82
    v_dot2c_f32_bf16 v81, v248, v248
    v_dot2c_f32_bf16 v80, v249, v82
    v_dot2c_f32_bf16 v81, v249, v249
    v_dot2c_f32_bf16 v80, v250, v82
    v_dot2c_f32_bf16 v81, v250, v250
    v_dot2c_f32_bf16 v80, v251, v82
    v_dot2c_f32_bf16 v81, v251, v251
    s_branch L_p1a_sdone
L_p1a_odd:
    v_dot2c_f32_bf16 v80, v132, v82
    v_dot2c_f32_bf16 v81, v132, v132
    v_dot2c_f32_bf16 v80, v133, v82
    v_dot2c_f32_bf16 v81, v133, v133
    v_dot2c_f32_bf16 v80, v134, v82
    v_dot2c_f32_bf16 v81, v134, v134
    v_dot2c_f32_bf16 v80, v135, v82
    v_dot2c_f32_bf16 v81, v135, v135
    v_dot2c_f32_bf16 v80, v140, v82
    v_dot2c_f32_bf16 v81, v140, v140
    v_dot2c_f32_bf16 v80, v141, v82
    v_dot2c_f32_bf16 v81, v141, v141
    v_dot2c_f32_bf16 v80, v142, v82
    v_dot2c_f32_bf16 v81, v142, v142
    v_dot2c_f32_bf16 v80, v143, v82
    v_dot2c_f32_bf16 v81, v143, v143
    v_dot2c_f32_bf16 v80, v148, v82
    v_dot2c_f32_bf16 v81, v148, v148
    v_dot2c_f32_bf16 v80, v149, v82
    v_dot2c_f32_bf16 v81, v149, v149
    v_dot2c_f32_bf16 v80, v150, v82
    v_dot2c_f32_bf16 v81, v150, v150
    v_dot2c_f32_bf16 v80, v151, v82
    v_dot2c_f32_bf16 v81, v151, v151
    v_dot2c_f32_bf16 v80, v156, v82
    v_dot2c_f32_bf16 v81, v156, v156
    v_dot2c_f32_bf16 v80, v157, v82
    v_dot2c_f32_bf16 v81, v157, v157
    v_dot2c_f32_bf16 v80, v158, v82
    v_dot2c_f32_bf16 v81, v158, v158
    v_dot2c_f32_bf16 v80, v159, v82
    v_dot2c_f32_bf16 v81, v159, v159
    v_dot2c_f32_bf16 v80, v164, v82
    v_dot2c_f32_bf16 v81, v164, v164
    v_dot2c_f32_bf16 v80, v165, v82
    v_dot2c_f32_bf16 v81, v165, v165
    v_dot2c_f32_bf16 v80, v166, v82
    v_dot2c_f32_bf16 v81, v166, v166
    v_dot2c_f32_bf16 v80, v167, v82
    v_dot2c_f32_bf16 v81, v167, v167
    v_dot2c_f32_bf16 v80, v172, v82
    v_dot2c_f32_bf16 v81, v172, v172
    v_dot2c_f32_bf16 v80, v173, v82
    v_dot2c_f32_bf16 v81, v173, v173
    v_dot2c_f32_bf16 v80, v174, v82
    v_dot2c_f32_bf16 v81, v174, v174
    v_dot2c_f32_bf16 v80, v175, v82
    v_dot2c_f32_bf16 v81, v175, v175
    v_dot2c_f32_bf16 v80, v180, v82
    v_dot2c_f32_bf16 v81, v180, v180
    v_dot2c_f32_bf16 v80, v181, v82
    v_dot2c_f32_bf16 v81, v181, v181
    v_dot2c_f32_bf16 v80, v182, v82
    v_dot2c_f32_bf16 v81, v182, v182
    v_dot2c_f32_bf16 v80, v183, v82
    v_dot2c_f32_bf16 v81, v183, v183
    v_dot2c_f32_bf16 v80, v188, v82
    v_dot2c_f32_bf16 v81, v188, v188
    v_dot2c_f32_bf16 v80, v189, v82
    v_dot2c_f32_bf16 v81, v189, v189
    v_dot2c_f32_bf16 v80, v190, v82
    v_dot2c_f32_bf16 v81, v190, v190
    v_dot2c_f32_bf16 v80, v191, v82
    v_dot2c_f32_bf16 v81, v191, v191
    v_dot2c_f32_bf16 v80, v196, v82
    v_dot2c_f32_bf16 v81, v196, v196
    v_dot2c_f32_bf16 v80, v197, v82
    v_dot2c_f32_bf16 v81, v197, v197
    v_dot2c_f32_bf16 v80, v198, v82
    v_dot2c_f32_bf16 v81, v198, v198
    v_dot2c_f32_bf16 v80, v199, v82
    v_dot2c_f32_bf16 v81, v199, v199
    v_dot2c_f32_bf16 v80, v204, v82
    v_dot2c_f32_bf16 v81, v204, v204
    v_dot2c_f32_bf16 v80, v205, v82
    v_dot2c_f32_bf16 v81, v205, v205
    v_dot2c_f32_bf16 v80, v206, v82
    v_dot2c_f32_bf16 v81, v206, v206
    v_dot2c_f32_bf16 v80, v207, v82
    v_dot2c_f32_bf16 v81, v207, v207
    v_dot2c_f32_bf16 v80, v212, v82
    v_dot2c_f32_bf16 v81, v212, v212
    v_dot2c_f32_bf16 v80, v213, v82
    v_dot2c_f32_bf16 v81, v213, v213
    v_dot2c_f32_bf16 v80, v214, v82
    v_dot2c_f32_bf16 v81, v214, v214
    v_dot2c_f32_bf16 v80, v215, v82
    v_dot2c_f32_bf16 v81, v215, v215
    v_dot2c_f32_bf16 v80, v220, v82
    v_dot2c_f32_bf16 v81, v220, v220
    v_dot2c_f32_bf16 v80, v221, v82
    v_dot2c_f32_bf16 v81, v221, v221
    v_dot2c_f32_bf16 v80, v222, v82
    v_dot2c_f32_bf16 v81, v222, v222
    v_dot2c_f32_bf16 v80, v223, v82
    v_dot2c_f32_bf16 v81, v223, v223
    v_dot2c_f32_bf16 v80, v228, v82
    v_dot2c_f32_bf16 v81, v228, v228
    v_dot2c_f32_bf16 v80, v229, v82
    v_dot2c_f32_bf16 v81, v229, v229
    v_dot2c_f32_bf16 v80, v230, v82
    v_dot2c_f32_bf16 v81, v230, v230
    v_dot2c_f32_bf16 v80, v231, v82
    v_dot2c_f32_bf16 v81, v231, v231
    v_dot2c_f32_bf16 v80, v236, v82
    v_dot2c_f32_bf16 v81, v236, v236
    v_dot2c_f32_bf16 v80, v237, v82
    v_dot2c_f32_bf16 v81, v237, v237
    v_dot2c_f32_bf16 v80, v238, v82
    v_dot2c_f32_bf16 v81, v238, v238
    v_dot2c_f32_bf16 v80, v239, v82
    v_dot2c_f32_bf16 v81, v239, v239
    v_dot2c_f32_bf16 v80, v244, v82
    v_dot2c_f32_bf16 v81, v244, v244
    v_dot2c_f32_bf16 v80, v245, v82
    v_dot2c_f32_bf16 v81, v245, v245
    v_dot2c_f32_bf16 v80, v246, v82
    v_dot2c_f32_bf16 v81, v246, v246
    v_dot2c_f32_bf16 v80, v247, v82
    v_dot2c_f32_bf16 v81, v247, v247
    v_dot2c_f32_bf16 v80, v252, v82
    v_dot2c_f32_bf16 v81, v252, v252
    v_dot2c_f32_bf16 v80, v253, v82
    v_dot2c_f32_bf16 v81, v253, v253
    v_dot2c_f32_bf16 v80, v254, v82
    v_dot2c_f32_bf16 v81, v254, v254
    v_dot2c_f32_bf16 v80, v255, v82
    v_dot2c_f32_bf16 v81, v255, v255
L_p1a_sdone:
    s_nop 4
    v_permlane32_swap_b32 v80, v81
    v_add_f32 v80, v80, v81
    v_lshrrev_b32 v83, 5, v0
    v_lshlrev_b32 v83, 8, v83
    v_add_u32 v83, v83, v13
    v_add_u32 v84, 160256, v83
    s_lshl_b32 s50, s43, 9
    v_add_u32 v85, s50, v84
    ds_write_b32 v85, v80
    s_waitcnt lgkmcnt(0)
    s_barrier
    s_barrier
    ds_read_b32 v86, v84 offset:0
    ds_read_b32 v87, v84 offset:512
    v_subrev_u32 v83, 4608, v84
    s_waitcnt lgkmcnt(0)
    v_add_f32 v86, v86, v87
    v_mov_b32 v88, v86
    s_nop 1
    v_permlane32_swap_b32 v86, v88
    v_mul_f32 v86, s82, v86
    v_mul_f32 v88, s82, v88
    v_fma_f32 v88, -v86, v86, v88
    v_max_f32 v88, 0, v88
    v_add_f32 v89, s83, v88
    v_rsq_f32 v89, v89
    s_nop 0
    v_cmp_gt_u32 s[70:71], 32, v0
    s_nop 1
    v_cndmask_b32 v91, v89, v86, s[70:71]
    ds_write_b32 v83, v91
    s_waitcnt lgkmcnt(0)
    ds_read_b128 v[64:67], v3 offset:0
    ds_read_b128 v[68:71], v3 offset:2048
    ds_read_b128 v[72:75], v3 offset:4096
    ds_read_b128 v[76:79], v3 offset:6144
    s_waitcnt lgkmcnt(3)
    v_mfma_f32_32x32x16_bf16 v[32:47], v[64:67], v[128:131], 0
    s_barrier
    ds_read_b128 v[64:67], v3 offset:8192
    s_waitcnt lgkmcnt(3)
    v_mfma_f32_32x32x16_bf16 v[32:47], v[68:71], v[132:135], v[32:47]
    ds_read_b128 v[68:71], v3 offset:10240
    s_waitcnt lgkmcnt(3)
    v_mfma_f32_32x32x16_bf16 v[32:47], v[72:75], v[136:139], v[32:47]
    ds_read_b128 v[72:75], v3 offset:12288
    s_waitcnt lgkmcnt(3)
    v_mfma_f32_32x32x16_bf16 v[32:47], v[76:79], v[140:143], v[32:47]
    ds_read_b128 v[76:79], v3 offset:14336
    s_waitcnt lgkmcnt(3)
    v_mfma_f32_32x32x16_bf16 v[32:47], v[64:67], v[144:147], v[32:47]
    s_barrier
    ds_read_b128 v[64:67], v3 offset:16384
    s_waitcnt lgkmcnt(3)
    v_mfma_f32_32x32x16_bf16 v[32:47], v[68:71], v[148:151], v[32:47]
    ds_read_b128 v[68:71], v3 offset:18432
    s_waitcnt lgkmcnt(3)
    v_mfma_f32_32x32x16_bf16 v[32:47], v[72:75], v[152:155], v[32:47]
    ds_read_b128 v[72:75], v3 offset:20480
    s_waitcnt lgkmcnt(3)
    v_mfma_f32_32x32x16_bf16 v[32:47], v[76:79], v[156:159], v[32:47]
    ds_read_b128 v[76:79], v3 offset:22528
    s_waitcnt lgkmcnt(3)
    v_mfma_f32_32x32x16_bf16 v[32:47], v[64:67], v[160:163], v[32:47]
    s_barrier
    ds_read_b128 v[64:67], v3 offset:24576
    s_waitcnt lgkmcnt(3)
    v_mfma_f32_32x32x16_bf16 v[32:47], v[68:71], v[164:167], v[32:47]
    ds_read_b128 v[68:71], v3 offset:26624
    s_waitcnt lgkmcnt(3)
    v_mfma_f32_32x32x16_bf16 v[32:47], v[72:75], v[168:171], v[32:47]
    ds_read_b128 v[72:75], v3 offset:28672
    s_waitcnt lgkmcnt(3)
    v_mfma_f32_32x32x16_bf16 v[32:47], v[76:79], v[172:175], v[32:47]
    ds_read_b128 v[76:79], v3 offset:30720
    s_waitcnt lgkmcnt(3)
    v_mfma_f32_32x32x16_bf16 v[32:47], v[64:67], v[176:179], v[32:47]
    s_barrier
    ds_read_b128 v[64:67], v3 offset:32768
    s_waitcnt lgkmcnt(3)
    v_mfma_f32_32x32x16_bf16 v[32:47], v[68:71], v[180:183], v[32:47]
    ds_read_b128 v[68:71], v3 offset:34816
    s_waitcnt lgkmcnt(3)
    v_mfma_f32_32x32x16_bf16 v[32:47], v[72:75], v[184:187], v[32:47]
    ds_read_b128 v[72:75], v3 offset:36864
    s_waitcnt lgkmcnt(3)
    v_mfma_f32_32x32x16_bf16 v[32:47], v[76:79], v[188:191], v[32:47]
    ds_read_b128 v[76:79], v3 offset:38912
    s_waitcnt lgkmcnt(3)
    v_mfma_f32_32x32x16_bf16 v[32:47], v[64:67], v[192:195], v[32:47]
    s_barrier
    ds_read_b128 v[64:67], v3 offset:40960
    s_waitcnt lgkmcnt(3)
    v_mfma_f32_32x32x16_bf16 v[32:47], v[68:71], v[196:199], v[32:47]
    ds_read_b128 v[68:71], v3 offset:43008
    s_waitcnt lgkmcnt(3)
    v_mfma_f32_32x32x16_bf16 v[32:47], v[72:75], v[200:203], v[32:47]
    ds_read_b128 v[72:75], v3 offset:45056
    s_waitcnt lgkmcnt(3)
    v_mfma_f32_32x32x16_bf16 v[32:47], v[76:79], v[204:207], v[32:47]
    ds_read_b128 v[76:79], v3 offset:47104
    s_waitcnt lgkmcnt(3)
    v_mfma_f32_32x32x16_bf16 v[32:47], v[64:67], v[208:211], v[32:47]
    s_barrier
    ds_read_b128 v[64:67], v3 offset:49152
    s_waitcnt lgkmcnt(3)
    v_mfma_f32_32x32x16_bf16 v[32:47], v[68:71], v[212:215], v[32:47]
    ds_read_b128 v[68:71], v3 offset:51200
    s_waitcnt lgkmcnt(3)
    v_mfma_f32_32x32x16_bf16 v[32:47], v[72:75], v[216:219], v[32:47]
    ds_read_b128 v[72:75], v3 offset:53248
    s_waitcnt lgkmcnt(3)
    v_mfma_f32_32x32x16_bf16 v[32:47], v[76:79], v[220:223], v[32:47]
    ds_read_b128 v[76:79], v3 offset:55296
    s_waitcnt lgkmcnt(3)
    v_mfma_f32_32x32x16_bf16 v[32:47], v[64:67], v[224:227], v[32:47]
    s_barrier
    ds_read_b128 v[64:67], v3 offset:57344
    s_waitcnt lgkmcnt(3)
    v_mfma_f32_32x32x16_bf16 v[32:47], v[68:71], v[228:231], v[32:47]
    ds_read_b128 v[68:71], v3 offset:59392
    s_waitcnt lgkmcnt(3)
    v_mfma_f32_32x32x16_bf16 v[32:47], v[72:75], v[232:235], v[32:47]
    ds_read_b128 v[72:75], v3 offset:61440
    s_waitcnt lgkmcnt(3)
    v_mfma_f32_32x32x16_bf16 v[32:47], v[76:79], v[236:239], v[32:47]
    ds_read_b128 v[76:79], v3 offset:63488
    s_waitcnt lgkmcnt(3)
    v_mfma_f32_32x32x16_bf16 v[32:47], v[64:67], v[240:243], v[32:47]
    s_barrier
    ds_read_b128 v[64:67], v4 offset:0
    s_waitcnt lgkmcnt(3)
    v_mfma_f32_32x32x16_bf16 v[32:47], v[68:71], v[244:247], v[32:47]
    ds_read_b128 v[68:71], v4 offset:2048
    s_waitcnt lgkmcnt(3)
    v_mfma_f32_32x32x16_bf16 v[32:47], v[72:75], v[248:251], v[32:47]
    ds_read_b128 v[72:75], v4 offset:4096
    s_waitcnt lgkmcnt(3)
    v_mfma_f32_32x32x16_bf16 v[32:47], v[76:79], v[252:255], v[32:47]
    ds_read_b128 v[76:79], v4 offset:6144
    s_waitcnt lgkmcnt(3)
    v_mfma_f32_32x32x16_bf16 v[48:63], v[128:131], v[64:67], 0
    s_barrier
    ds_read_b128 v[64:67], v4 offset:8192
    s_waitcnt lgkmcnt(3)
    v_mfma_f32_32x32x16_bf16 v[48:63], v[132:135], v[68:71], v[48:63]
    ds_read_b128 v[68:71], v4 offset:10240
    s_waitcnt lgkmcnt(3)
    v_mfma_f32_32x32x16_bf16 v[48:63], v[136:139], v[72:75], v[48:63]
    ds_read_b128 v[72:75], v4 offset:12288
    s_waitcnt lgkmcnt(3)
    v_mfma_f32_32x32x16_bf16 v[48:63], v[140:143], v[76:79], v[48:63]
    ds_read_b128 v[76:79], v4 offset:14336
    v_add_u32 v82, 155648, v13
    v_add_u32 v83, 155648, v12
    ds_read_b32 v80, v82 offset:0
    ds_read_b32 v81, v82 offset:256
    s_waitcnt lgkmcnt(5)
    v_mfma_f32_32x32x16_bf16 v[48:63], v[144:147], v[64:67], v[48:63]
    s_barrier
    ds_read_b128 v[64:67], v4 offset:16384
    ds_read_b128 v[96:99], v83 offset:5632
    ds_read_b128 v[100:103], v83 offset:5664
    ds_read_b128 v[104:107], v83 offset:5696
    ds_read_b128 v[108:111], v83 offset:5728
    s_waitcnt lgkmcnt(9)
    v_mfma_f32_32x32x16_bf16 v[48:63], v[148:151], v[68:71], v[48:63]
    ds_read_b128 v[68:71], v4 offset:18432
    s_waitcnt lgkmcnt(9)
    v_mfma_f32_32x32x16_bf16 v[48:63], v[152:155], v[72:75], v[48:63]
    ds_read_b128 v[72:75], v4 offset:20480
    s_waitcnt lgkmcnt(5)
    v_fma_f32 v92, -v80, v96, v32
    v_fma_f32 v93, -v80, v97, v33
    v_mfma_f32_32x32x16_bf16 v[48:63], v[156:159], v[76:79], v[48:63]
    ds_read_b128 v[76:79], v4 offset:22528
    v_fma_f32 v94, -v80, v98, v34
    v_fma_f32 v95, -v80, v99, v35
    v_mul_f32 v92, v92, v81
    v_mul_f32 v93, v93, v81
    v_mfma_f32_32x32x16_bf16 v[48:63], v[160:163], v[64:67], v[48:63]
    s_barrier
    ds_read_b128 v[64:67], v3 offset:0
    v_mul_f32 v94, v94, v81
    v_mul_f32 v95, v95, v81
    v_cvt_pk_bf16_f32 v84, v92, v93
    v_cvt_pk_bf16_f32 v85, v94, v95
    s_waitcnt lgkmcnt(3)
    v_mfma_f32_32x32x16_bf16 v[48:63], v[164:167], v[68:71], v[48:63]
    ds_read_b128 v[68:71], v3 offset:2048
    v_fma_f32 v92, -v80, v100, v36
    v_fma_f32 v93, -v80, v101, v37
    v_fma_f32 v94, -v80, v102, v38
    v_fma_f32 v95, -v80, v103, v39
    s_waitcnt lgkmcnt(3)
    v_mfma_f32_32x32x16_bf16 v[48:63], v[168:171], v[72:75], v[48:63]
    ds_read_b128 v[72:75], v3 offset:4096
    v_mul_f32 v92, v92, v81
    v_mul_f32 v93, v93, v81
    v_mul_f32 v94, v94, v81
    v_mul_f32 v95, v95, v81
    s_waitcnt lgkmcnt(3)
    v_mfma_f32_32x32x16_bf16 v[48:63], v[172:175], v[76:79], v[48:63]
    ds_read_b128 v[76:79], v3 offset:6144
    v_cvt_pk_bf16_f32 v86, v92, v93
    v_cvt_pk_bf16_f32 v87, v94, v95
    v_fma_f32 v92, -v80, v104, v40
    v_fma_f32 v93, -v80, v105, v41
    s_waitcnt lgkmcnt(3)
    v_mfma_f32_32x32x16_bf16 v[48:63], v[176:179], v[64:67], v[48:63]
    s_barrier
    ds_read_b128 v[64:67], v3 offset:8192
    v_fma_f32 v94, -v80, v106, v42
    v_fma_f32 v95, -v80, v107, v43
    v_mul_f32 v92, v92, v81
    v_mul_f32 v93, v93, v81
    s_waitcnt lgkmcnt(3)
    v_mfma_f32_32x32x16_bf16 v[48:63], v[180:183], v[68:71], v[48:63]
    ds_read_b128 v[68:71], v3 offset:10240
    v_mul_f32 v94, v94, v81
    v_mul_f32 v95, v95, v81
    v_cvt_pk_bf16_f32 v88, v92, v93
    v_cvt_pk_bf16_f32 v89, v94, v95
    s_waitcnt lgkmcnt(3)
    v_mfma_f32_32x32x16_bf16 v[48:63], v[184:187], v[72:75], v[48:63]
    ds_read_b128 v[72:75], v3 offset:12288
    v_fma_f32 v92, -v80, v108, v44
    v_fma_f32 v93, -v80, v109, v45
    v_fma_f32 v94, -v80, v110, v46
    v_fma_f32 v95, -v80, v111, v47
    s_waitcnt lgkmcnt(3)
    v_mfma_f32_32x32x16_bf16 v[48:63], v[188:191], v[76:79], v[48:63]
    ds_read_b128 v[76:79], v3 offset:14336
    v_mul_f32 v92, v92, v81
    v_mul_f32 v93, v93, v81
    v_mul_f32 v94, v94, v81
    v_mul_f32 v95, v95, v81
    s_waitcnt lgkmcnt(3)
    v_mfma_f32_32x32x16_bf16 v[48:63], v[192:195], v[64:67], v[48:63]
    s_barrier
    ds_read_b128 v[64:67], v3 offset:16384
    v_cvt_pk_bf16_f32 v90, v92, v93
    v_cvt_pk_bf16_f32 v91, v94, v95
    s_lshl_b32 s50, s42, 12
    s_lshl_b32 s51, s43, 11
    s_waitcnt lgkmcnt(3)
    v_mfma_f32_32x32x16_bf16 v[48:63], v[196:199], v[68:71], v[48:63]
    ds_read_b128 v[68:71], v3 offset:18432
    s_add_u32 s50, s50, s51
    v_add_u32 v82, s50, v1
    ds_write_b128 v82, v[84:87] offset:32768
    s_waitcnt lgkmcnt(4)
    v_mfma_f32_32x32x16_bf16 v[48:63], v[200:203], v[72:75], v[48:63]
    ds_read_b128 v[72:75], v3 offset:20480
    ds_write_b128 v82, v[88:91] offset:33792
    s_waitcnt lgkmcnt(5)
    v_mfma_f32_32x32x16_bf16 v[48:63], v[204:207], v[76:79], v[48:63]
    ds_read_b128 v[76:79], v3 offset:22528
    buffer_store_dwordx4 v[84:87], v1, s[24:27], s58 offen offset:0 sc1
    buffer_store_dwordx4 v[88:91], v1, s[24:27], s58 offen offset:1024 sc1
    s_waitcnt lgkmcnt(5)
    v_mfma_f32_32x32x16_bf16 v[48:63], v[208:211], v[64:67], v[48:63]
    s_barrier
    ds_read_b128 v[64:67], v3 offset:24576
    s_waitcnt lgkmcnt(5)
    v_mfma_f32_32x32x16_bf16 v[48:63], v[212:215], v[68:71], v[48:63]
    ds_read_b128 v[68:71], v3 offset:26624
    s_waitcnt lgkmcnt(4)
    v_mfma_f32_32x32x16_bf16 v[48:63], v[216:219], v[72:75], v[48:63]
    ds_read_b128 v[72:75], v3 offset:28672
    s_waitcnt lgkmcnt(3)
    v_mfma_f32_32x32x16_bf16 v[48:63], v[220:223], v[76:79], v[48:63]
    ds_read_b128 v[76:79], v3 offset:30720
    s_waitcnt lgkmcnt(3)
    v_mfma_f32_32x32x16_bf16 v[48:63], v[224:227], v[64:67], v[48:63]
    s_barrier
    ds_read_b128 v[64:67], v3 offset:32768
    s_waitcnt lgkmcnt(3)
    v_mfma_f32_32x32x16_bf16 v[48:63], v[228:231], v[68:71], v[48:63]
    ds_read_b128 v[68:71], v3 offset:34816
    s_waitcnt lgkmcnt(3)
    v_mfma_f32_32x32x16_bf16 v[48:63], v[232:235], v[72:75], v[48:63]
    ds_read_b128 v[72:75], v3 offset:36864
    s_waitcnt lgkmcnt(3)
    v_mfma_f32_32x32x16_bf16 v[48:63], v[236:239], v[76:79], v[48:63]
    ds_read_b128 v[76:79], v3 offset:38912
    s_waitcnt lgkmcnt(3)
    v_mfma_f32_32x32x16_bf16 v[48:63], v[240:243], v[64:67], v[48:63]
    s_barrier
    ds_read_b128 v[64:67], v2 offset:0
    s_waitcnt lgkmcnt(3)
    v_mfma_f32_32x32x16_bf16 v[48:63], v[244:247], v[68:71], v[48:63]
    ds_read_b128 v[68:71], v2 offset:2048
    s_waitcnt lgkmcnt(3)
    v_mfma_f32_32x32x16_bf16 v[48:63], v[248:251], v[72:75], v[48:63]
    ds_read_b128 v[72:75], v2 offset:4096
    s_waitcnt lgkmcnt(3)
    v_mfma_f32_32x32x16_bf16 v[48:63], v[252:255], v[76:79], v[48:63]
    ds_read_b128 v[76:79], v2 offset:6144
    s_waitcnt lgkmcnt(3)
    v_mfma_f32_32x32x16_bf16 v[32:47], v[64:67], v[128:131], 0
    s_barrier
    ds_read_b128 v[64:67], v2 offset:8192
    s_waitcnt lgkmcnt(3)
    v_mfma_f32_32x32x16_bf16 v[32:47], v[68:71], v[132:135], v[32:47]
    ds_read_b128 v[68:71], v2 offset:10240
    s_waitcnt lgkmcnt(3)
    v_mfma_f32_32x32x16_bf16 v[32:47], v[72:75], v[136:139], v[32:47]
    ds_read_b128 v[72:75], v2 offset:12288
    s_waitcnt lgkmcnt(3)
    v_mfma_f32_32x32x16_bf16 v[32:47], v[76:79], v[140:143], v[32:47]
    ds_read_b128 v[76:79], v2 offset:14336
    v_and_b32 v82, 31, v0
    v_lshlrev_b32 v82, 2, v82
    s_lshl_b32 s50, s43, 7
    s_add_u32 s50, s50, 155648
    s_waitcnt lgkmcnt(3)
    v_mfma_f32_32x32x16_bf16 v[32:47], v[64:67], v[144:147], v[32:47]
    s_barrier
    ds_read_b128 v[64:67], v2 offset:16384
    v_add_u32 v82, s50, v82
    v_add_u32 v83, 155648, v14
    ds_read_b32 v80, v82 offset:5888
    ds_read_b128 v[96:99], v83 offset:0
    s_waitcnt lgkmcnt(5)
    v_mfma_f32_32x32x16_bf16 v[32:47], v[68:71], v[148:151], v[32:47]
    ds_read_b128 v[68:71], v2 offset:18432
    ds_read_b128 v[100:103], v83 offset:256
    s_waitcnt lgkmcnt(6)
    v_mfma_f32_32x32x16_bf16 v[32:47], v[72:75], v[152:155], v[32:47]
    ds_read_b128 v[72:75], v2 offset:20480
    ds_read_b128 v[104:107], v83 offset:32
    s_waitcnt lgkmcnt(7)
    v_mfma_f32_32x32x16_bf16 v[32:47], v[76:79], v[156:159], v[32:47]
    ds_read_b128 v[76:79], v2 offset:22528
    ds_read_b128 v[108:111], v83 offset:288
    s_waitcnt lgkmcnt(6)
    v_fma_f32 v92, -v96, v80, v48
    v_fma_f32 v93, -v97, v80, v49
    v_fma_f32 v94, -v98, v80, v50
    v_mfma_f32_32x32x16_bf16 v[32:47], v[64:67], v[160:163], v[32:47]
    s_barrier
    ds_read_b128 v[64:67], v2 offset:24576
    v_fma_f32 v95, -v99, v80, v51
    s_waitcnt lgkmcnt(5)
    v_mul_f32 v92, v92, v100
    v_mul_f32 v93, v93, v101
    v_mul_f32 v94, v94, v102
    v_mfma_f32_32x32x16_bf16 v[32:47], v[68:71], v[164:167], v[32:47]
    ds_read_b128 v[68:71], v2 offset:26624
    v_mul_f32 v95, v95, v103
    v_cvt_pk_bf16_f32 v84, v92, v93
    v_cvt_pk_bf16_f32 v85, v94, v95
    ds_read_b128 v[96:99], v83 offset:64
    s_waitcnt lgkmcnt(6)
    v_mfma_f32_32x32x16_bf16 v[32:47], v[72:75], v[168:171], v[32:47]
    ds_read_b128 v[72:75], v2 offset:28672
    ds_read_b128 v[100:103], v83 offset:320
    s_waitcnt lgkmcnt(7)
    v_fma_f32 v92, -v104, v80, v52
    v_fma_f32 v93, -v105, v80, v53
    v_fma_f32 v94, -v106, v80, v54
    s_waitcnt lgkmcnt(6)
    v_mfma_f32_32x32x16_bf16 v[32:47], v[76:79], v[172:175], v[32:47]
    ds_read_b128 v[76:79], v2 offset:30720
    v_fma_f32 v95, -v107, v80, v55
    s_waitcnt lgkmcnt(6)
    v_mul_f32 v92, v92, v108
    v_mul_f32 v93, v93, v109
    v_mul_f32 v94, v94, v110
    s_waitcnt lgkmcnt(5)
    v_mfma_f32_32x32x16_bf16 v[32:47], v[64:67], v[176:179], v[32:47]
    s_barrier
    ds_read_b128 v[64:67], v2 offset:40960
    v_mul_f32 v95, v95, v111
    v_cvt_pk_bf16_f32 v86, v92, v93
    v_cvt_pk_bf16_f32 v87, v94, v95
    ds_read_b128 v[104:107], v83 offset:96
    s_waitcnt lgkmcnt(6)
    v_mfma_f32_32x32x16_bf16 v[32:47], v[68:71], v[180:183], v[32:47]
    ds_read_b128 v[68:71], v2 offset:43008
    ds_read_b128 v[108:111], v83 offset:352
    s_waitcnt lgkmcnt(7)
    v_fma_f32 v92, -v96, v80, v56
    v_fma_f32 v93, -v97, v80, v57
    v_fma_f32 v94, -v98, v80, v58
    s_waitcnt lgkmcnt(6)
    v_mfma_f32_32x32x16_bf16 v[32:47], v[72:75], v[184:187], v[32:47]
    ds_read_b128 v[72:75], v2 offset:45056
    v_fma_f32 v95, -v99, v80, v59
    s_waitcnt lgkmcnt(6)
    v_mul_f32 v92, v92, v100
    v_mul_f32 v93, v93, v101
    v_mul_f32 v94, v94, v102
    s_waitcnt lgkmcnt(5)
    v_mfma_f32_32x32x16_bf16 v[32:47], v[76:79], v[188:191], v[32:47]
    ds_read_b128 v[76:79], v2 offset:47104
    v_mul_f32 v95, v95, v103
    v_cvt_pk_bf16_f32 v88, v92, v93
    v_cvt_pk_bf16_f32 v89, v94, v95
    s_waitcnt lgkmcnt(4)
    v_fma_f32 v92, -v104, v80, v60
    v_mfma_f32_32x32x16_bf16 v[32:47], v[64:67], v[192:195], v[32:47]
    s_barrier
    ds_read_b128 v[64:67], v2 offset:49152
    v_fma_f32 v93, -v105, v80, v61
    v_fma_f32 v94, -v106, v80, v62
    v_fma_f32 v95, -v107, v80, v63
    s_waitcnt lgkmcnt(3)
    v_mul_f32 v92, v92, v108
    v_mfma_f32_32x32x16_bf16 v[32:47], v[68:71], v[196:199], v[32:47]
    ds_read_b128 v[68:71], v2 offset:51200
    v_mul_f32 v93, v93, v109
    v_mul_f32 v94, v94, v110
    v_mul_f32 v95, v95, v111
    v_cvt_pk_bf16_f32 v90, v92, v93
    s_waitcnt lgkmcnt(3)
    v_mfma_f32_32x32x16_bf16 v[32:47], v[72:75], v[200:203], v[32:47]
    ds_read_b128 v[72:75], v2 offset:53248
    v_cvt_pk_bf16_f32 v91, v94, v95
    v_bfe_u32 v82, v0, 4, 1
    v_lshlrev_b32 v82, 10, v82
    v_lshrrev_b32 v81, 5, v0
    s_waitcnt lgkmcnt(3)
    v_mfma_f32_32x32x16_bf16 v[32:47], v[76:79], v[204:207], v[32:47]
    ds_read_b128 v[76:79], v2 offset:55296
    v_lshl_add_u32 v82, v81, 8, v82
    v_and_b32 v81, 15, v0
    v_lshl_add_u32 v82, v81, 4, v82
    s_lshl_b32 s50, s42, 12
    s_waitcnt lgkmcnt(3)
    v_mfma_f32_32x32x16_bf16 v[32:47], v[64:67], v[208:211], v[32:47]
    s_waitcnt vmcnt(0)
    s_barrier
    ds_read_b128 v[64:67], v2 offset:57344
    s_lshl_b32 s51, s43, 11
    s_add_u32 s50, s50, s51
    s_add_u32 s50, s50, 73728
    v_add_u32 v83, s50, v82
    s_waitcnt lgkmcnt(3)
    v_mfma_f32_32x32x16_bf16 v[32:47], v[68:71], v[212:215], v[32:47]
    ds_read_b128 v[68:71], v2 offset:59392
    s_add_u32 s51, s58, 8192
    ds_write_b128 v83, v[84:87] offset:0
    s_waitcnt lgkmcnt(4)
    v_mfma_f32_32x32x16_bf16 v[32:47], v[72:75], v[216:219], v[32:47]
    ds_read_b128 v[72:75], v2 offset:61440
    ds_write_b128 v83, v[88:91] offset:512
    s_waitcnt lgkmcnt(5)
    v_mfma_f32_32x32x16_bf16 v[32:47], v[76:79], v[220:223], v[32:47]
    ds_read_b128 v[76:79], v2 offset:63488
    buffer_store_dwordx4 v[84:87], v82, s[24:27], s51 offen offset:0 sc1
    buffer_store_dwordx4 v[88:91], v82, s[24:27], s51 offen offset:512 sc1
    s_waitcnt lgkmcnt(5)
    v_mfma_f32_32x32x16_bf16 v[32:47], v[64:67], v[224:227], v[32:47]
    s_barrier
    ds_read_b128 v[64:67], v3 offset:0
    s_waitcnt lgkmcnt(5)
    v_mfma_f32_32x32x16_bf16 v[32:47], v[68:71], v[228:231], v[32:47]
    ds_read_b128 v[68:71], v3 offset:2048
    s_waitcnt lgkmcnt(4)
    v_mfma_f32_32x32x16_bf16 v[32:47], v[72:75], v[232:235], v[32:47]
    ds_read_b128 v[72:75], v3 offset:4096
    s_waitcnt lgkmcnt(3)
    v_mfma_f32_32x32x16_bf16 v[32:47], v[76:79], v[236:239], v[32:47]
    ds_read_b128 v[76:79], v3 offset:6144
    s_waitcnt lgkmcnt(3)
    v_mfma_f32_32x32x16_bf16 v[32:47], v[64:67], v[240:243], v[32:47]
    s_waitcnt lgkmcnt(2)
    v_mfma_f32_32x32x16_bf16 v[32:47], v[68:71], v[244:247], v[32:47]
    s_waitcnt lgkmcnt(1)
    v_mfma_f32_32x32x16_bf16 v[32:47], v[72:75], v[248:251], v[32:47]
    s_waitcnt lgkmcnt(0)
    v_mfma_f32_32x32x16_bf16 v[32:47], v[76:79], v[252:255], v[32:47]
    s_nop 11
    s_barrier
    v_add_u32 v82, 155648, v13
    v_add_u32 v83, 155648, v12
    ds_read_b32 v80, v82 offset:0
    ds_read_b32 v81, v82 offset:256
    ds_read_b128 v[96:99], v83 offset:6144
    ds_read_b128 v[100:103], v83 offset:6176
    ds_read_b128 v[104:107], v83 offset:6208
    ds_read_b128 v[108:111], v83 offset:6240
    s_waitcnt lgkmcnt(4)
    v_mul_f32 v81, s84, v81
    s_waitcnt lgkmcnt(3)
    v_fma_f32 v92, -v80, v96, v32
    v_fma_f32 v93, -v80, v97, v33
    v_fma_f32 v94, -v80, v98, v34
    v_fma_f32 v95, -v80, v99, v35
    v_mul_f32 v92, v92, v81
    v_mul_f32 v93, v93, v81
    v_mul_f32 v94, v94, v81
    v_mul_f32 v95, v95, v81
    v_cvt_pk_bf16_f32 v84, v92, v93
    v_cvt_pk_bf16_f32 v85, v94, v95
    s_waitcnt lgkmcnt(2)
    v_fma_f32 v92, -v80, v100, v36
    v_fma_f32 v93, -v80, v101, v37
    v_fma_f32 v94, -v80, v102, v38
    v_fma_f32 v95, -v80, v103, v39
    v_mul_f32 v92, v92, v81
    v_mul_f32 v93, v93, v81
    v_mul_f32 v94, v94, v81
    v_mul_f32 v95, v95, v81
    v_cvt_pk_bf16_f32 v86, v92, v93
    v_cvt_pk_bf16_f32 v87, v94, v95
    s_waitcnt lgkmcnt(1)
    v_fma_f32 v92, -v80, v104, v40
    v_fma_f32 v93, -v80, v105, v41
    v_fma_f32 v94, -v80, v106, v42
    v_fma_f32 v95, -v80, v107, v43
    v_mul_f32 v92, v92, v81
    v_mul_f32 v93, v93, v81
    v_mul_f32 v94, v94, v81
    v_mul_f32 v95, v95, v81
    v_cvt_pk_bf16_f32 v88, v92, v93
    v_cvt_pk_bf16_f32 v89, v94, v95
    s_waitcnt lgkmcnt(0)
    v_fma_f32 v92, -v80, v108, v44
    v_fma_f32 v93, -v80, v109, v45
    v_fma_f32 v94, -v80, v110, v46
    v_fma_f32 v95, -v80, v111, v47
    v_mul_f32 v92, v92, v81
    v_mul_f32 v93, v93, v81
    v_mul_f32 v94, v94, v81
    v_mul_f32 v95, v95, v81
    v_cvt_pk_bf16_f32 v90, v92, v93
    v_cvt_pk_bf16_f32 v91, v94, v95
    s_lshl_b32 s50, s42, 10
    s_lshl_b32 s51, s43, 12
    s_add_u32 s50, s50, s51
    s_add_u32 s50, s50, 81920
    v_add_u32 v82, s50, v1
    ds_write_b128 v82, v[84:87] offset:0
    ds_write_b128 v82, v[88:91] offset:2048
    s_waitcnt vmcnt(0) lgkmcnt(0)
    v_mov_b32 v80, 162820
    v_mov_b32 v81, 1
    s_mov_b64 exec, 1
    ds_add_u32 v80, v81
    s_mov_b64 exec, -1
    s_cmp_lg_u32 s38, 0
    s_cbranch_scc1 L_p1a_vm_x
    s_mov_b32 s60, 400000
L_p1a_vm:
    ds_read_b32 v81, v80
    s_waitcnt lgkmcnt(0)
    v_cmp_gt_u32 vcc, 8, v81
    s_sub_u32 s60, s60, 1
    s_cbranch_scc1 L_p1a_vm_y
    s_cbranch_vccnz L_p1a_vm
L_p1a_vm_y:
    s_cmp_lg_u32 s38, 0
    s_cbranch_scc1 L_p1a_vf_skip
    s_lshl_b32 s50, s36, 3
    s_add_u32 s50, s50, s37
    s_lshl_b32 s50, s50, 7
    s_add_u32 s50, s50, 8196
    s_add_u32 s74, s85, 1
    s_add_u32 s74, s74, s87
    v_mov_b32 v81, s74
    v_mov_b32 v82, s50
    s_mov_b64 s[70:71], exec
    s_mov_b64 exec, 1
    buffer_store_dword v81, v82, s[24:27], 0 offen sc1
    s_mov_b64 exec, s[70:71]
L_p1a_vf_skip:
L_p1a_vm_x:
    s_waitcnt lgkmcnt(0)
    s_barrier
L_c_loop:
    s_cmp_lg_u32 s40, 0
    s_cbranch_scc1 c_mode
    v_mov_b32 v121, 162816
    ds_read_b32 v121, v121
    s_waitcnt lgkmcnt(0)
    v_readfirstlane_b32 s41, v121
c_mode:
    s_and_b32 s50, s38, 3
    s_lshr_b32 s51, s38, 2
    s_lshl_b32 s52, s50, 10
    s_lshl_b32 s49, s51, 12
    s_add_u32 s52, s52, s49
    v_add_u32 v208, s52, v1
    v_lshrrev_b32 v121, 5, v0
    v_lshlrev_b32 v121, 8, v121
    v_and_b32 v122, 15, v0
    v_lshl_add_u32 v121, v122, 4, v121
    s_add_u32 s52, s52, 40960
    v_add_u32 v209, s52, v121
    s_lshl_b32 s52, s50, 11
    s_lshl_b32 s49, s51, 10
    s_add_u32 s52, s52, s49
    s_add_u32 s52, s52, 81920
    v_add_u32 v210, s52, v1
    s_lshl_b32 s52, s36, 1
    s_add_u32 s52, s52, s51
    s_sub_i32 s72, 8, s52
    s_max_i32 s72, s72, 0
    s_mul_i32 s73, s36, 180224
    s_add_u32 s73, s73, 3145728
    s_lshl_b32 s52, s51, 15
    s_add_u32 s73, s73, s52
    s_lshl_b32 s52, s37, 2
    s_add_u32 s52, s52, s50
    s_lshl_b32 s52, s52, 10
    s_add_u32 s73, s73, s52
    v_and_b32 v121, 31, v0
    v_lshrrev_b32 v122, 5, v0
    v_lshlrev_b32 v122, 2, v122
    v_sub_u32 v121, v121, v122
    v_mov_b32 v120, 4048155338
    v_mov_b32 v122, 0
    v_cmp_le_i32 s[88:89], 0, v121
    s_nop 1
    v_cndmask_b32 v128, v120, v122, s[88:89]
    v_cndmask_b32 v144, v122, v120, s[88:89]
    v_cmp_le_i32 s[90:91], 1, v121
    s_nop 1
    v_cndmask_b32 v129, v120, v122, s[90:91]
    v_cndmask_b32 v145, v122, v120, s[90:91]
    v_cmp_le_i32 s[88:89], 2, v121
    s_nop 1
    v_cndmask_b32 v130, v120, v122, s[88:89]
    v_cndmask_b32 v146, v122, v120, s[88:89]
    v_cmp_le_i32 s[90:91], 3, v121
    s_nop 1
    v_cndmask_b32 v131, v120, v122, s[90:91]
    v_cndmask_b32 v147, v122, v120, s[90:91]
    v_cmp_le_i32 s[88:89], 8, v121
    s_nop 1
    v_cndmask_b32 v132, v120, v122, s[88:89]
    v_cndmask_b32 v148, v122, v120, s[88:89]
    v_cmp_le_i32 s[90:91], 9, v121
    s_nop 1
    v_cndmask_b32 v133, v120, v122, s[90:91]
    v_cndmask_b32 v149, v122, v120, s[90:91]
    v_cmp_le_i32 s[88:89], 10, v121
    s_nop 1
    v_cndmask_b32 v134, v120, v122, s[88:89]
    v_cndmask_b32 v150, v122, v120, s[88:89]
    v_cmp_le_i32 s[90:91], 11, v121
    s_nop 1
    v_cndmask_b32 v135, v120, v122, s[90:91]
    v_cndmask_b32 v151, v122, v120, s[90:91]
    v_cmp_le_i32 s[88:89], 16, v121
    s_nop 1
    v_cndmask_b32 v136, v120, v122, s[88:89]
    v_cndmask_b32 v152, v122, v120, s[88:89]
    v_cmp_le_i32 s[90:91], 17, v121
    s_nop 1
    v_cndmask_b32 v137, v120, v122, s[90:91]
    v_cndmask_b32 v153, v122, v120, s[90:91]
    v_cmp_le_i32 s[88:89], 18, v121
    s_nop 1
    v_cndmask_b32 v138, v120, v122, s[88:89]
    v_cndmask_b32 v154, v122, v120, s[88:89]
    v_cmp_le_i32 s[90:91], 19, v121
    s_nop 1
    v_cndmask_b32 v139, v120, v122, s[90:91]
    v_cndmask_b32 v155, v122, v120, s[90:91]
    v_cmp_le_i32 s[88:89], 24, v121
    s_nop 1
    v_cndmask_b32 v140, v120, v122, s[88:89]
    v_cndmask_b32 v156, v122, v120, s[88:89]
    v_cmp_le_i32 s[90:91], 25, v121
    s_nop 1
    v_cndmask_b32 v141, v120, v122, s[90:91]
    v_cndmask_b32 v157, v122, v120, s[90:91]
    v_cmp_le_i32 s[88:89], 26, v121
    s_nop 1
    v_cndmask_b32 v142, v120, v122, s[88:89]
    v_cndmask_b32 v158, v122, v120, s[88:89]
    v_cmp_le_i32 s[90:91], 27, v121
    s_nop 1
    v_cndmask_b32 v143, v120, v122, s[90:91]
    v_cndmask_b32 v159, v122, v120, s[90:91]
    v_mov_b32 v104, 0x3f803f80
    v_mov_b32 v105, 0x3f803f80
    v_mov_b32 v106, 0x3f803f80
    v_mov_b32 v107, 0x3f803f80
    v_mov_b32 v108, 0x3f803f80
    v_mov_b32 v109, 0x3f803f80
    v_mov_b32 v110, 0x3f803f80
    v_mov_b32 v111, 0x3f803f80
    v_mov_b32 v112, 0x3f803f80
    v_mov_b32 v113, 0x3f803f80
    v_mov_b32 v114, 0x3f803f80
    v_mov_b32 v115, 0x3f803f80
    v_mov_b32 v116, 0x3f803f80
    v_mov_b32 v117, 0x3f803f80
    v_mov_b32 v118, 0x3f803f80
    v_mov_b32 v119, 0x3f803f80
    s_barrier
    s_branch L_attn
L_c_postattn:
    s_lshl_b32 s50, s36, 7
    s_lshl_b32 s51, s37, 2
    s_add_u32 s51, s51, s50
    s_lshl_b32 s74, s40, 2
    s_add_u32 s74, s74, 1
    s_add_u32 s74, s74, s87
    v_mov_b32 v81, s51
    v_mov_b32 v83, s74
    v_and_b32 v82, 7, v0
    v_lshlrev_b32 v82, 2, v82
    v_add_u32 v82, s50, v82
    s_mov_b32 s60, 400000
    s_barrier
    s_cmp_lg_u32 s38, 0
    s_cbranch_scc1 L_o_skip
    s_mov_b64 exec, 1
    s_cmp_eq_u32 s41, 0
    s_cbranch_scc1 L_o_sl
    buffer_store_dword v83, v81, s[24:27], 0 offen
    s_branch L_o_st
L_o_sl:
    buffer_store_dword v83, v81, s[24:27], 0 offen sc1
L_o_st:
    s_mov_b64 exec, -1
L_o_p:
    buffer_load_dword v80, v82, s[24:27], 0 offen sc1
    s_waitcnt vmcnt(0)
    v_subrev_u32 v80, s74, v80
    v_cmp_le_u32 vcc, 8, v80
    s_sub_u32 s60, s60, 1
    s_cbranch_scc1 L_o_p_x
    s_cbranch_vccnz L_o_p
L_o_p_x:
L_o_skip:
    s_barrier
    s_lshl_b32 s51, s42, 15
    s_add_u32 s51, s51, s54
    s_lshl_b32 s52, s43, 10
    s_add_u32 s51, s51, s52
    s_add_u32 s50, s51, 0
    buffer_load_dwordx4 v[128:131], v1, s[24:27], s50 offen sc1
    s_add_u32 s50, s51, 2048
    buffer_load_dwordx4 v[132:135], v1, s[24:27], s50 offen sc1
    s_add_u32 s50, s51, 4096
    buffer_load_dwordx4 v[136:139], v1, s[24:27], s50 offen sc1
    s_add_u32 s50, s51, 6144
    buffer_load_dwordx4 v[140:143], v1, s[24:27], s50 offen sc1
    s_add_u32 s50, s51, 8192
    buffer_load_dwordx4 v[144:147], v1, s[24:27], s50 offen sc1
    s_add_u32 s50, s51, 10240
    buffer_load_dwordx4 v[148:151], v1, s[24:27], s50 offen sc1
    s_add_u32 s50, s51, 12288
    buffer_load_dwordx4 v[152:155], v1, s[24:27], s50 offen sc1
    s_add_u32 s50, s51, 14336
    buffer_load_dwordx4 v[156:159], v1, s[24:27], s50 offen sc1
    s_add_u32 s50, s51, 16384
    buffer_load_dwordx4 v[160:163], v1, s[24:27], s50 offen sc1
    s_add_u32 s50, s51, 18432
    buffer_load_dwordx4 v[164:167], v1, s[24:27], s50 offen sc1
    s_add_u32 s50, s51, 20480
    buffer_load_dwordx4 v[168:171], v1, s[24:27], s50 offen sc1
    s_add_u32 s50, s51, 22528
    buffer_load_dwordx4 v[172:175], v1, s[24:27], s50 offen sc1
    s_add_u32 s50, s51, 24576
    buffer_load_dwordx4 v[176:179], v1, s[24:27], s50 offen sc1
    s_add_u32 s50, s51, 26624
    buffer_load_dwordx4 v[180:183], v1, s[24:27], s50 offen sc1
    s_add_u32 s50, s51, 28672
    buffer_load_dwordx4 v[184:187], v1, s[24:27], s50 offen sc1
    s_add_u32 s50, s51, 30720
    buffer_load_dwordx4 v[188:191], v1, s[24:27], s50 offen sc1
    ds_read_b128 v[64:67], v6 offset:24576
    ds_read_b128 v[68:71], v9 offset:24576
    ds_read_b128 v[72:75], v6 offset:28672
    ds_read_b128 v[76:79], v9 offset:28672
    s_waitcnt vmcnt(15)
    s_waitcnt lgkmcnt(2)
    v_mfma_f32_32x32x16_bf16 v[32:47], v[64:67], v[128:131], 0
    ds_read_b128 v[80:83], v6 offset:32768
    ds_read_b128 v[84:87], v9 offset:32768
    v_mfma_f32_32x32x16_bf16 v[48:63], v[68:71], v[128:131], 0
    s_waitcnt vmcnt(14)
    s_waitcnt lgkmcnt(2)
    v_mfma_f32_32x32x16_bf16 v[32:47], v[72:75], v[132:135], v[32:47]
    ds_read_b128 v[64:67], v6 offset:36864
    ds_read_b128 v[68:71], v9 offset:36864
    v_mfma_f32_32x32x16_bf16 v[48:63], v[76:79], v[132:135], v[48:63]
    s_waitcnt vmcnt(13)
    s_waitcnt lgkmcnt(2)
    v_mfma_f32_32x32x16_bf16 v[32:47], v[80:83], v[136:139], v[32:47]
    ds_read_b128 v[72:75], v6 offset:40960
    ds_read_b128 v[76:79], v9 offset:40960
    v_mfma_f32_32x32x16_bf16 v[48:63], v[84:87], v[136:139], v[48:63]
    s_waitcnt vmcnt(12)
    s_waitcnt lgkmcnt(2)
    v_mfma_f32_32x32x16_bf16 v[32:47], v[64:67], v[140:143], v[32:47]
    ds_read_b128 v[80:83], v6 offset:45056
    ds_read_b128 v[84:87], v9 offset:45056
    v_mfma_f32_32x32x16_bf16 v[48:63], v[68:71], v[140:143], v[48:63]
    s_waitcnt vmcnt(11)
    s_waitcnt lgkmcnt(2)
    v_mfma_f32_32x32x16_bf16 v[32:47], v[72:75], v[144:147], v[32:47]
    ds_read_b128 v[64:67], v6 offset:49152
    ds_read_b128 v[68:71], v9 offset:49152
    v_mfma_f32_32x32x16_bf16 v[48:63], v[76:79], v[144:147], v[48:63]
    s_waitcnt vmcnt(10)
    s_waitcnt lgkmcnt(2)
    v_mfma_f32_32x32x16_bf16 v[32:47], v[80:83], v[148:151], v[32:47]
    ds_read_b128 v[72:75], v6 offset:53248
    ds_read_b128 v[76:79], v9 offset:53248
    v_mfma_f32_32x32x16_bf16 v[48:63], v[84:87], v[148:151], v[48:63]
    s_waitcnt vmcnt(9)
    s_waitcnt lgkmcnt(2)
    v_mfma_f32_32x32x16_bf16 v[32:47], v[64:67], v[152:155], v[32:47]
    ds_read_b128 v[80:83], v6 offset:57344
    ds_read_b128 v[84:87], v9 offset:57344
    v_mfma_f32_32x32x16_bf16 v[48:63], v[68:71], v[152:155], v[48:63]
    s_waitcnt vmcnt(8)
    s_waitcnt lgkmcnt(2)
    v_mfma_f32_32x32x16_bf16 v[32:47], v[72:75], v[156:159], v[32:47]
    ds_read_b128 v[64:67], v6 offset:61440
    ds_read_b128 v[68:71], v9 offset:61440
    v_mfma_f32_32x32x16_bf16 v[48:63], v[76:79], v[156:159], v[48:63]
    s_waitcnt vmcnt(7)
    s_waitcnt lgkmcnt(2)
    v_mfma_f32_32x32x16_bf16 v[32:47], v[80:83], v[160:163], v[32:47]
    ds_read_b128 v[72:75], v7 offset:0
    ds_read_b128 v[76:79], v10 offset:0
    v_mfma_f32_32x32x16_bf16 v[48:63], v[84:87], v[160:163], v[48:63]
    s_waitcnt vmcnt(6)
    s_waitcnt lgkmcnt(2)
    v_mfma_f32_32x32x16_bf16 v[32:47], v[64:67], v[164:167], v[32:47]
    ds_read_b128 v[80:83], v7 offset:4096
    ds_read_b128 v[84:87], v10 offset:4096
    v_mfma_f32_32x32x16_bf16 v[48:63], v[68:71], v[164:167], v[48:63]
    s_waitcnt vmcnt(5)
    s_waitcnt lgkmcnt(2)
    v_mfma_f32_32x32x16_bf16 v[32:47], v[72:75], v[168:171], v[32:47]
    s_barrier
    ds_read_b128 v[64:67], v7 offset:8192
    ds_read_b128 v[68:71], v10 offset:8192
    v_mfma_f32_32x32x16_bf16 v[48:63], v[76:79], v[168:171], v[48:63]
    s_waitcnt vmcnt(4)
    s_waitcnt lgkmcnt(2)
    v_mfma_f32_32x32x16_bf16 v[32:47], v[80:83], v[172:175], v[32:47]
    ds_read_b128 v[72:75], v7 offset:12288
    ds_read_b128 v[76:79], v10 offset:12288
    v_mfma_f32_32x32x16_bf16 v[48:63], v[84:87], v[172:175], v[48:63]
    s_waitcnt vmcnt(3)
    s_waitcnt lgkmcnt(2)
    v_mfma_f32_32x32x16_bf16 v[32:47], v[64:67], v[176:179], v[32:47]
    ds_read_b128 v[80:83], v7 offset:16384
    ds_read_b128 v[84:87], v10 offset:16384
    v_mfma_f32_32x32x16_bf16 v[48:63], v[68:71], v[176:179], v[48:63]
    s_waitcnt vmcnt(2)
    s_waitcnt lgkmcnt(2)
    v_mfma_f32_32x32x16_bf16 v[32:47], v[72:75], v[180:183], v[32:47]
    ds_read_b128 v[64:67], v7 offset:20480
    ds_read_b128 v[68:71], v10 offset:20480
    v_mfma_f32_32x32x16_bf16 v[48:63], v[76:79], v[180:183], v[48:63]
    s_waitcnt vmcnt(1)
    s_waitcnt lgkmcnt(2)
    v_mfma_f32_32x32x16_bf16 v[32:47], v[80:83], v[184:187], v[32:47]
    v_mfma_f32_32x32x16_bf16 v[48:63], v[84:87], v[184:187], v[48:63]
    s_waitcnt vmcnt(0)
    s_waitcnt lgkmcnt(0)
    v_mfma_f32_32x32x16_bf16 v[32:47], v[64:67], v[188:191], v[32:47]
    v_mfma_f32_32x32x16_bf16 v[48:63], v[68:71], v[188:191], v[48:63]
    s_lshl_b32 s50, s38, 12
    s_add_u32 s50, s50, 73728
    v_add_u32 v96, s50, v1
    s_xor_b32 s51, s38, 1
    s_lshl_b32 s51, s51, 12
    s_add_u32 s51, s51, 73728
    v_add_u32 v97, s51, v1
    s_nop 7
    ds_write_b128 v96, v[48:51] offset:0
    ds_write_b128 v96, v[52:55] offset:1024
    ds_write_b128 v96, v[56:59] offset:2048
    ds_write_b128 v96, v[60:63] offset:3072
    s_waitcnt lgkmcnt(0)
    s_barrier
    ds_read_b128 v[80:83], v97 offset:0
    ds_read_b128 v[84:87], v97 offset:1024
    ds_read_b128 v[88:91], v97 offset:2048
    ds_read_b128 v[92:95], v97 offset:3072
    v_pk_add_f32 v[16:17], v[16:17], v[32:33]
    v_pk_add_f32 v[18:19], v[18:19], v[34:35]
    v_pk_add_f32 v[20:21], v[20:21], v[36:37]
    v_pk_add_f32 v[22:23], v[22:23], v[38:39]
    v_pk_add_f32 v[24:25], v[24:25], v[40:41]
    v_pk_add_f32 v[26:27], v[26:27], v[42:43]
    v_pk_add_f32 v[28:29], v[28:29], v[44:45]
    v_pk_add_f32 v[30:31], v[30:31], v[46:47]
    s_waitcnt lgkmcnt(0)
    v_pk_add_f32 v[16:17], v[16:17], v[80:81]
    v_pk_add_f32 v[18:19], v[18:19], v[82:83]
    v_pk_add_f32 v[20:21], v[20:21], v[84:85]
    v_pk_add_f32 v[22:23], v[22:23], v[86:87]
    v_pk_add_f32 v[24:25], v[24:25], v[88:89]
    v_pk_add_f32 v[26:27], v[26:27], v[90:91]
    v_pk_add_f32 v[28:29], v[28:29], v[92:93]
    v_pk_add_f32 v[30:31], v[30:31], v[94:95]
    v_cvt_pk_bf16_f32 v116, v16, v17
    v_cvt_pk_bf16_f32 v117, v18, v19
    v_cvt_pk_bf16_f32 v118, v20, v21
    v_cvt_pk_bf16_f32 v119, v22, v23
    v_cvt_pk_bf16_f32 v120, v24, v25
    v_cvt_pk_bf16_f32 v121, v26, v27
    v_cvt_pk_bf16_f32 v122, v28, v29
    v_cvt_pk_bf16_f32 v123, v30, v31
    s_cmp_eq_u32 s41, 0
    s_cbranch_scc1 c_ds1596_s
    buffer_store_dwordx4 v[116:119], v1, s[24:27], s53 offen nt
    s_branch c_ds1596_e
c_ds1596_s:
    buffer_store_dwordx4 v[116:119], v1, s[24:27], s53 offen sc1
c_ds1596_e:
    s_cmp_eq_u32 s41, 0
    s_cbranch_scc1 c_ds1603_s
    buffer_store_dwordx4 v[120:123], v1, s[24:27], s53 offen offset:1024 nt
    s_branch c_ds1603_e
c_ds1603_s:
    buffer_store_dwordx4 v[120:123], v1, s[24:27], s53 offen offset:1024 sc1
c_ds1603_e:
    v_pk_add_f32 v[100:101], v[16:17], v[18:19]
    v_pk_mul_f32 v[102:103], v[16:17], v[16:17]
    v_pk_fma_f32 v[102:103], v[18:19], v[18:19], v[102:103]
    v_pk_add_f32 v[100:101], v[100:101], v[20:21]
    v_pk_fma_f32 v[102:103], v[20:21], v[20:21], v[102:103]
    v_pk_add_f32 v[100:101], v[100:101], v[22:23]
    v_pk_fma_f32 v[102:103], v[22:23], v[22:23], v[102:103]
    v_pk_add_f32 v[100:101], v[100:101], v[24:25]
    v_pk_fma_f32 v[102:103], v[24:25], v[24:25], v[102:103]
    v_pk_add_f32 v[100:101], v[100:101], v[26:27]
    v_pk_fma_f32 v[102:103], v[26:27], v[26:27], v[102:103]
    v_pk_add_f32 v[100:101], v[100:101], v[28:29]
    v_pk_fma_f32 v[102:103], v[28:29], v[28:29], v[102:103]
    v_pk_add_f32 v[100:101], v[100:101], v[30:31]
    v_pk_fma_f32 v[102:103], v[30:31], v[30:31], v[102:103]
    v_add_f32 v100, v100, v101
    v_add_f32 v102, v102, v103
    s_lshl_b32 s50, s37, 1
    s_add_u32 s50, s50, s43
    s_lshr_b32 s51, s50, 2
    s_lshl_b32 s51, s51, 10
    s_and_b32 s50, s50, 3
    s_lshl_b32 s50, s50, 2
    s_add_u32 s50, s50, s51
    s_lshl_b32 s51, s42, 12
    s_add_u32 s50, s50, s51
    s_add_u32 s50, s50, s59
    v_permlane32_swap_b32 v100, v102
    v_add_f32 v100, v100, v102
    s_nop 0
    s_cmp_eq_u32 s41, 0
    s_cbranch_scc1 c_ds1640_s
    buffer_store_dword v100, v1, s[24:27], s50 offen nt
    s_branch c_ds1640_e
c_ds1640_s:
    buffer_store_dword v100, v1, s[24:27], s50 offen sc1
c_ds1640_e:
    s_lshl_b32 s50, s36, 7
    s_lshl_b32 s51, s37, 2
    s_add_u32 s51, s51, s50
    s_lshl_b32 s74, s40, 2
    s_add_u32 s74, s74, 2
    s_add_u32 s74, s74, s87
    v_mov_b32 v81, s51
    v_mov_b32 v83, s74
    v_and_b32 v82, 7, v0
    v_lshlrev_b32 v82, 2, v82
    v_add_u32 v82, s50, v82
    s_mov_b32 s60, 400000
    s_waitcnt vmcnt(0) lgkmcnt(0)
    s_barrier
    s_cmp_lg_u32 s38, 0
    s_cbranch_scc1 L_x1_skip
    s_mov_b64 exec, 1
    s_cmp_eq_u32 s41, 0
    s_cbranch_scc1 L_x1_sl
    buffer_store_dword v83, v81, s[24:27], 0 offen
    s_branch L_x1_st
L_x1_sl:
    buffer_store_dword v83, v81, s[24:27], 0 offen sc1
L_x1_st:
    s_mov_b64 exec, -1
L_x1_p:
    buffer_load_dword v80, v82, s[24:27], 0 offen sc1
    s_waitcnt vmcnt(0)
    v_subrev_u32 v80, s74, v80
    v_cmp_le_u32 vcc, 8, v80
    s_sub_u32 s60, s60, 1
    s_cbranch_scc1 L_x1_p_x
    s_cbranch_vccnz L_x1_p
L_x1_p_x:
L_x1_skip:
    s_barrier
    v_add_u32 v115, 90112, v11
    s_barrier
    ds_read_b128 v[64:67], v2 offset:0
    ds_read_b128 v[128:131], v115 offset:0
    ds_read_b128 v[68:71], v2 offset:2048
    ds_read_b128 v[132:135], v115 offset:2048
    ds_read_b128 v[72:75], v2 offset:4096
    ds_read_b128 v[136:139], v115 offset:4096
    ds_read_b128 v[76:79], v2 offset:6144
    ds_read_b128 v[140:143], v115 offset:6144
    s_waitcnt lgkmcnt(6)
    v_mfma_f32_32x32x16_bf16 v[32:47], v[64:67], v[128:131], 0
    s_barrier
    ds_read_b128 v[64:67], v2 offset:8192
    ds_read_b128 v[144:147], v115 offset:8192
    s_waitcnt lgkmcnt(6)
    v_mfma_f32_32x32x16_bf16 v[32:47], v[68:71], v[132:135], v[32:47]
    ds_read_b128 v[68:71], v2 offset:10240
    ds_read_b128 v[148:151], v115 offset:10240
    s_waitcnt lgkmcnt(6)
    v_mfma_f32_32x32x16_bf16 v[32:47], v[72:75], v[136:139], v[32:47]
    ds_read_b128 v[72:75], v2 offset:12288
    ds_read_b128 v[152:155], v115 offset:12288
    s_waitcnt lgkmcnt(6)
    v_mfma_f32_32x32x16_bf16 v[32:47], v[76:79], v[140:143], v[32:47]
    ds_read_b128 v[76:79], v2 offset:14336
    ds_read_b128 v[156:159], v115 offset:14336
    s_waitcnt lgkmcnt(6)
    v_mfma_f32_32x32x16_bf16 v[32:47], v[64:67], v[144:147], v[32:47]
    s_barrier
    ds_read_b128 v[64:67], v2 offset:16384
    ds_read_b128 v[160:163], v115 offset:16384
    s_waitcnt lgkmcnt(6)
    v_mfma_f32_32x32x16_bf16 v[32:47], v[68:71], v[148:151], v[32:47]
    ds_read_b128 v[68:71], v2 offset:18432
    ds_read_b128 v[164:167], v115 offset:18432
    s_waitcnt lgkmcnt(6)
    v_mfma_f32_32x32x16_bf16 v[32:47], v[72:75], v[152:155], v[32:47]
    ds_read_b128 v[72:75], v2 offset:20480
    ds_read_b128 v[168:171], v115 offset:20480
    s_waitcnt lgkmcnt(6)
    v_mfma_f32_32x32x16_bf16 v[32:47], v[76:79], v[156:159], v[32:47]
    ds_read_b128 v[76:79], v2 offset:22528
    ds_read_b128 v[172:175], v115 offset:22528
    s_waitcnt lgkmcnt(6)
    v_mfma_f32_32x32x16_bf16 v[32:47], v[64:67], v[160:163], v[32:47]
    s_barrier
    ds_read_b128 v[64:67], v2 offset:24576
    ds_read_b128 v[176:179], v115 offset:24576
    s_waitcnt lgkmcnt(6)
    v_mfma_f32_32x32x16_bf16 v[32:47], v[68:71], v[164:167], v[32:47]
    ds_read_b128 v[68:71], v2 offset:26624
    ds_read_b128 v[180:183], v115 offset:26624
    s_waitcnt lgkmcnt(6)
    v_mfma_f32_32x32x16_bf16 v[32:47], v[72:75], v[168:171], v[32:47]
    ds_read_b128 v[72:75], v2 offset:28672
    ds_read_b128 v[184:187], v115 offset:28672
    s_waitcnt lgkmcnt(6)
    v_mfma_f32_32x32x16_bf16 v[32:47], v[76:79], v[172:175], v[32:47]
    ds_read_b128 v[76:79], v2 offset:30720
    ds_read_b128 v[188:191], v115 offset:30720
    s_waitcnt lgkmcnt(6)
    v_mfma_f32_32x32x16_bf16 v[32:47], v[64:67], v[176:179], v[32:47]
    s_barrier
    ds_read_b128 v[64:67], v2 offset:32768
    ds_read_b128 v[192:195], v115 offset:32768
    s_waitcnt lgkmcnt(6)
    v_mfma_f32_32x32x16_bf16 v[32:47], v[68:71], v[180:183], v[32:47]
    ds_read_b128 v[68:71], v2 offset:34816
    ds_read_b128 v[196:199], v115 offset:34816
    s_waitcnt lgkmcnt(6)
    v_mfma_f32_32x32x16_bf16 v[32:47], v[72:75], v[184:187], v[32:47]
    ds_read_b128 v[72:75], v2 offset:36864
    ds_read_b128 v[200:203], v115 offset:36864
    s_waitcnt lgkmcnt(6)
    v_mfma_f32_32x32x16_bf16 v[32:47], v[76:79], v[188:191], v[32:47]
    ds_read_b128 v[76:79], v2 offset:38912
    ds_read_b128 v[204:207], v115 offset:38912
    s_waitcnt lgkmcnt(6)
    v_mfma_f32_32x32x16_bf16 v[32:47], v[64:67], v[192:195], v[32:47]
    s_barrier
    ds_read_b128 v[64:67], v2 offset:40960
    ds_read_b128 v[208:211], v115 offset:40960
    s_waitcnt lgkmcnt(6)
    v_mfma_f32_32x32x16_bf16 v[32:47], v[68:71], v[196:199], v[32:47]
    ds_read_b128 v[68:71], v2 offset:43008
    ds_read_b128 v[212:215], v115 offset:43008
    s_waitcnt lgkmcnt(6)
    v_mfma_f32_32x32x16_bf16 v[32:47], v[72:75], v[200:203], v[32:47]
    ds_read_b128 v[72:75], v2 offset:45056
    ds_read_b128 v[216:219], v115 offset:45056
    s_waitcnt lgkmcnt(6)
    v_mfma_f32_32x32x16_bf16 v[32:47], v[76:79], v[204:207], v[32:47]
    ds_read_b128 v[76:79], v2 offset:47104
    ds_read_b128 v[220:223], v115 offset:47104
    s_waitcnt lgkmcnt(6)
    v_mfma_f32_32x32x16_bf16 v[32:47], v[64:67], v[208:211], v[32:47]
    s_barrier
    ds_read_b128 v[64:67], v2 offset:49152
    ds_read_b128 v[224:227], v115 offset:49152
    s_waitcnt lgkmcnt(6)
    v_mfma_f32_32x32x16_bf16 v[32:47], v[68:71], v[212:215], v[32:47]
    ds_read_b128 v[68:71], v2 offset:51200
    ds_read_b128 v[228:231], v115 offset:51200
    s_waitcnt lgkmcnt(6)
    v_mfma_f32_32x32x16_bf16 v[32:47], v[72:75], v[216:219], v[32:47]
    ds_read_b128 v[72:75], v2 offset:53248
    ds_read_b128 v[232:235], v115 offset:53248
    s_waitcnt lgkmcnt(6)
    v_mfma_f32_32x32x16_bf16 v[32:47], v[76:79], v[220:223], v[32:47]
    ds_read_b128 v[76:79], v2 offset:55296
    ds_read_b128 v[236:239], v115 offset:55296
    s_waitcnt lgkmcnt(6)
    v_mfma_f32_32x32x16_bf16 v[32:47], v[64:67], v[224:227], v[32:47]
    s_barrier
    ds_read_b128 v[64:67], v2 offset:57344
    ds_read_b128 v[240:243], v115 offset:57344
    s_waitcnt lgkmcnt(6)
    v_mfma_f32_32x32x16_bf16 v[32:47], v[68:71], v[228:231], v[32:47]
    ds_read_b128 v[68:71], v2 offset:59392
    ds_read_b128 v[244:247], v115 offset:59392
    s_waitcnt lgkmcnt(6)
    v_mfma_f32_32x32x16_bf16 v[32:47], v[72:75], v[232:235], v[32:47]
    ds_read_b128 v[72:75], v2 offset:61440
    ds_read_b128 v[248:251], v115 offset:61440
    s_waitcnt lgkmcnt(6)
    v_mfma_f32_32x32x16_bf16 v[32:47], v[76:79], v[236:239], v[32:47]
    ds_read_b128 v[76:79], v2 offset:63488
    ds_read_b128 v[252:255], v115 offset:63488
    s_waitcnt lgkmcnt(6)
    v_mfma_f32_32x32x16_bf16 v[32:47], v[64:67], v[240:243], v[32:47]
    s_barrier
    ds_read_b128 v[64:67], v3 offset:0
    s_waitcnt lgkmcnt(5)
    v_mfma_f32_32x32x16_bf16 v[32:47], v[68:71], v[244:247], v[32:47]
    ds_read_b128 v[68:71], v3 offset:2048
    s_waitcnt lgkmcnt(4)
    v_mfma_f32_32x32x16_bf16 v[32:47], v[72:75], v[248:251], v[32:47]
    ds_read_b128 v[72:75], v3 offset:4096
    s_waitcnt lgkmcnt(3)
    v_mfma_f32_32x32x16_bf16 v[32:47], v[76:79], v[252:255], v[32:47]
    ds_read_b128 v[76:79], v3 offset:6144
    s_waitcnt lgkmcnt(3)
    v_mfma_f32_32x32x16_bf16 v[48:63], v[64:67], v[128:131], 0
    s_barrier
    ds_read_b128 v[64:67], v3 offset:8192
    s_waitcnt lgkmcnt(3)
    v_mfma_f32_32x32x16_bf16 v[48:63], v[68:71], v[132:135], v[48:63]
    ds_read_b128 v[68:71], v3 offset:10240
    s_waitcnt lgkmcnt(3)
    v_mfma_f32_32x32x16_bf16 v[48:63], v[72:75], v[136:139], v[48:63]
    ds_read_b128 v[72:75], v3 offset:12288
    s_waitcnt lgkmcnt(3)
    v_mfma_f32_32x32x16_bf16 v[48:63], v[76:79], v[140:143], v[48:63]
    ds_read_b128 v[76:79], v3 offset:14336
    v_add_u32 v83, 155648, v13
    ds_read_b32 v80, v83 offset:0
    ds_read_b32 v81, v83 offset:256
    v_add_u32 v83, 155648, v12
    v_mov_b32 v82, 3184710632
    ds_read_b128 v[100:103], v83 offset:6400
    ds_read_b128 v[104:107], v83 offset:3584
    s_waitcnt lgkmcnt(7)
    v_mfma_f32_32x32x16_bf16 v[48:63], v[64:67], v[144:147], v[48:63]
    s_barrier
    ds_read_b128 v[64:67], v3 offset:16384
    s_waitcnt lgkmcnt(3)
    v_mul_f32 v80, v80, v81
    s_waitcnt lgkmcnt(1)
    v_fma_f32 v104, -v80, v100, v104
    v_mfma_f32_32x32x16_bf16 v[48:63], v[68:71], v[148:151], v[48:63]
    ds_read_b128 v[68:71], v3 offset:18432
    v_fma_f32 v105, -v80, v101, v105
    v_fma_f32 v106, -v80, v102, v106
    v_fma_f32 v107, -v80, v103, v107
    v_fma_f32 v92, v32, v81, v104
    v_fma_f32 v93, v33, v81, v105
    v_fma_f32 v94, v34, v81, v106
    v_fma_f32 v95, v35, v81, v107
    v_mfma_f32_32x32x16_bf16 v[48:63], v[72:75], v[152:155], v[48:63]
    ds_read_b128 v[72:75], v3 offset:20480
    ds_read_b128 v[108:111], v83 offset:6432
    ds_read_b128 v[112:115], v83 offset:3616
    v_mul_f32 v96, v92, v92
    v_mul_f32 v97, v93, v93
    v_mul_f32 v98, v94, v94
    v_mul_f32 v99, v95, v95
    v_fmaak_f32 v96, v96, v82, 3222493025
    v_mfma_f32_32x32x16_bf16 v[48:63], v[76:79], v[156:159], v[48:63]
    ds_read_b128 v[76:79], v3 offset:22528
    v_fmaak_f32 v97, v97, v82, 3222493025
    v_fmaak_f32 v98, v98, v82, 3222493025
    v_fmaak_f32 v99, v99, v82, 3222493025
    v_mul_f32 v96, v96, v92
    v_mul_f32 v97, v97, v93
    v_mul_f32 v98, v98, v94
    v_mul_f32 v99, v99, v95
    s_waitcnt lgkmcnt(5)
    v_mfma_f32_32x32x16_bf16 v[48:63], v[64:67], v[160:163], v[48:63]
    s_barrier
    ds_read_b128 v[64:67], v2 offset:0
    v_exp_f32 v96, v96
    v_exp_f32 v97, v97
    v_exp_f32 v98, v98
    v_exp_f32 v99, v99
    v_add_f32 v96, 1.0, v96
    v_add_f32 v97, 1.0, v97
    v_add_f32 v98, 1.0, v98
    s_waitcnt lgkmcnt(5)
    v_mfma_f32_32x32x16_bf16 v[48:63], v[68:71], v[164:167], v[48:63]
    ds_read_b128 v[68:71], v2 offset:2048
    v_add_f32 v99, 1.0, v99
    v_rcp_f32 v96, v96
    v_rcp_f32 v97, v97
    v_rcp_f32 v98, v98
    v_rcp_f32 v99, v99
    v_mul_f32 v92, v92, v96
    v_mul_f32 v93, v93, v97
    s_waitcnt lgkmcnt(5)
    v_mfma_f32_32x32x16_bf16 v[48:63], v[72:75], v[168:171], v[48:63]
    ds_read_b128 v[72:75], v2 offset:4096
    v_mul_f32 v94, v94, v98
    v_mul_f32 v95, v95, v99
    v_cvt_pk_bf16_f32 v84, v92, v93
    v_cvt_pk_bf16_f32 v85, v94, v95
    s_waitcnt lgkmcnt(4)
    v_fma_f32 v112, -v80, v108, v112
    v_fma_f32 v113, -v80, v109, v113
    s_waitcnt lgkmcnt(3)
    v_mfma_f32_32x32x16_bf16 v[48:63], v[76:79], v[172:175], v[48:63]
    ds_read_b128 v[76:79], v2 offset:6144
    v_fma_f32 v114, -v80, v110, v114
    v_fma_f32 v115, -v80, v111, v115
    v_fma_f32 v92, v36, v81, v112
    v_fma_f32 v93, v37, v81, v113
    v_fma_f32 v94, v38, v81, v114
    v_fma_f32 v95, v39, v81, v115
    s_waitcnt lgkmcnt(3)
    v_mfma_f32_32x32x16_bf16 v[48:63], v[64:67], v[176:179], v[48:63]
    s_barrier
    ds_read_b128 v[64:67], v2 offset:8192
    ds_read_b128 v[100:103], v83 offset:6464
    ds_read_b128 v[104:107], v83 offset:3648
    v_mul_f32 v96, v92, v92
    v_mul_f32 v97, v93, v93
    v_mul_f32 v98, v94, v94
    v_mul_f32 v99, v95, v95
    s_waitcnt lgkmcnt(5)
    v_mfma_f32_32x32x16_bf16 v[48:63], v[68:71], v[180:183], v[48:63]
    ds_read_b128 v[68:71], v2 offset:10240
    v_fmaak_f32 v96, v96, v82, 3222493025
    v_fmaak_f32 v97, v97, v82, 3222493025
    v_fmaak_f32 v98, v98, v82, 3222493025
    v_fmaak_f32 v99, v99, v82, 3222493025
    v_mul_f32 v96, v96, v92
    v_mul_f32 v97, v97, v93
    s_waitcnt lgkmcnt(5)
    v_mfma_f32_32x32x16_bf16 v[48:63], v[72:75], v[184:187], v[48:63]
    ds_read_b128 v[72:75], v2 offset:12288
    v_mul_f32 v98, v98, v94
    v_mul_f32 v99, v99, v95
    v_exp_f32 v96, v96
    v_exp_f32 v97, v97
    v_exp_f32 v98, v98
    v_exp_f32 v99, v99
    s_waitcnt lgkmcnt(5)
    v_mfma_f32_32x32x16_bf16 v[48:63], v[76:79], v[188:191], v[48:63]
    ds_read_b128 v[76:79], v2 offset:14336
    v_add_f32 v96, 1.0, v96
    v_add_f32 v97, 1.0, v97
    v_add_f32 v98, 1.0, v98
    v_add_f32 v99, 1.0, v99
    v_rcp_f32 v96, v96
    v_rcp_f32 v97, v97
    s_waitcnt lgkmcnt(5)
    v_mfma_f32_32x32x16_bf16 v[48:63], v[64:67], v[192:195], v[48:63]
    s_barrier
    ds_read_b128 v[64:67], v2 offset:16384
    v_rcp_f32 v98, v98
    v_rcp_f32 v99, v99
    v_mul_f32 v92, v92, v96
    v_mul_f32 v93, v93, v97
    v_mul_f32 v94, v94, v98
    v_mul_f32 v95, v95, v99
    s_waitcnt lgkmcnt(3)
    v_mfma_f32_32x32x16_bf16 v[48:63], v[68:71], v[196:199], v[48:63]
    ds_read_b128 v[68:71], v2 offset:18432
    v_cvt_pk_bf16_f32 v86, v92, v93
    v_cvt_pk_bf16_f32 v87, v94, v95
    s_nop 0
    v_fma_f32 v104, -v80, v100, v104
    v_fma_f32 v105, -v80, v101, v105
    s_waitcnt lgkmcnt(3)
    v_mfma_f32_32x32x16_bf16 v[48:63], v[72:75], v[200:203], v[48:63]
    ds_read_b128 v[72:75], v2 offset:20480
    v_fma_f32 v106, -v80, v102, v106
    v_fma_f32 v107, -v80, v103, v107
    v_fma_f32 v92, v40, v81, v104
    v_fma_f32 v93, v41, v81, v105
    v_fma_f32 v94, v42, v81, v106
    v_fma_f32 v95, v43, v81, v107
    s_waitcnt lgkmcnt(3)
    v_mfma_f32_32x32x16_bf16 v[48:63], v[76:79], v[204:207], v[48:63]
    ds_read_b128 v[76:79], v2 offset:22528
    ds_read_b128 v[108:111], v83 offset:6496
    ds_read_b128 v[112:115], v83 offset:3680
    v_mul_f32 v96, v92, v92
    v_mul_f32 v97, v93, v93
    v_mul_f32 v98, v94, v94
    v_mul_f32 v99, v95, v95
    s_cmp_eq_u32 s41, 0
    s_cbranch_scc1 c_ds1993_s
    buffer_store_dwordx4 v[84:87], v1, s[24:27], s61 offen nt
    s_branch c_ds1993_e
c_ds1993_s:
    buffer_store_dwordx4 v[84:87], v1, s[24:27], s61 offen sc1
c_ds1993_e:
    s_waitcnt lgkmcnt(5)
    v_mfma_f32_32x32x16_bf16 v[48:63], v[64:67], v[208:211], v[48:63]
    s_barrier
    ds_read_b128 v[64:67], v2 offset:24576
    v_fmaak_f32 v96, v96, v82, 3222493025
    v_fmaak_f32 v97, v97, v82, 3222493025
    v_fmaak_f32 v98, v98, v82, 3222493025
    v_fmaak_f32 v99, v99, v82, 3222493025
    v_mul_f32 v96, v96, v92
    v_mul_f32 v97, v97, v93
    s_waitcnt lgkmcnt(5)
    v_mfma_f32_32x32x16_bf16 v[48:63], v[68:71], v[212:215], v[48:63]
    ds_read_b128 v[68:71], v2 offset:26624
    v_mul_f32 v98, v98, v94
    v_mul_f32 v99, v99, v95
    v_exp_f32 v96, v96
    v_exp_f32 v97, v97
    v_exp_f32 v98, v98
    v_exp_f32 v99, v99
    s_waitcnt lgkmcnt(5)
    v_mfma_f32_32x32x16_bf16 v[48:63], v[72:75], v[216:219], v[48:63]
    ds_read_b128 v[72:75], v2 offset:28672
    v_add_f32 v96, 1.0, v96
    v_add_f32 v97, 1.0, v97
    v_add_f32 v98, 1.0, v98
    v_add_f32 v99, 1.0, v99
    v_rcp_f32 v96, v96
    v_rcp_f32 v97, v97
    s_waitcnt lgkmcnt(5)
    v_mfma_f32_32x32x16_bf16 v[48:63], v[76:79], v[220:223], v[48:63]
    ds_read_b128 v[76:79], v2 offset:30720
    v_rcp_f32 v98, v98
    v_rcp_f32 v99, v99
    v_mul_f32 v92, v92, v96
    v_mul_f32 v93, v93, v97
    v_mul_f32 v94, v94, v98
    v_mul_f32 v95, v95, v99
    s_waitcnt lgkmcnt(3)
    v_mfma_f32_32x32x16_bf16 v[48:63], v[64:67], v[224:227], v[48:63]
    s_barrier
    ds_read_b128 v[64:67], v2 offset:32768
    v_cvt_pk_bf16_f32 v88, v92, v93
    v_cvt_pk_bf16_f32 v89, v94, v95
    v_fma_f32 v112, -v80, v108, v112
    v_fma_f32 v113, -v80, v109, v113
    v_fma_f32 v114, -v80, v110, v114
    v_fma_f32 v115, -v80, v111, v115
    s_waitcnt lgkmcnt(3)
    v_mfma_f32_32x32x16_bf16 v[48:63], v[68:71], v[228:231], v[48:63]
    ds_read_b128 v[68:71], v2 offset:34816
    v_fma_f32 v92, v44, v81, v112
    v_fma_f32 v93, v45, v81, v113
    v_fma_f32 v94, v46, v81, v114
    v_fma_f32 v95, v47, v81, v115
    v_mul_f32 v96, v92, v92
    v_mul_f32 v97, v93, v93
    s_waitcnt lgkmcnt(3)
    v_mfma_f32_32x32x16_bf16 v[48:63], v[72:75], v[232:235], v[48:63]
    ds_read_b128 v[72:75], v2 offset:36864
    v_mul_f32 v98, v94, v94
    v_mul_f32 v99, v95, v95
    v_fmaak_f32 v96, v96, v82, 3222493025
    v_fmaak_f32 v97, v97, v82, 3222493025
    v_fmaak_f32 v98, v98, v82, 3222493025
    v_fmaak_f32 v99, v99, v82, 3222493025
    s_waitcnt lgkmcnt(3)
    v_mfma_f32_32x32x16_bf16 v[48:63], v[76:79], v[236:239], v[48:63]
    ds_read_b128 v[76:79], v2 offset:38912
    v_mul_f32 v96, v96, v92
    v_mul_f32 v97, v97, v93
    v_mul_f32 v98, v98, v94
    v_mul_f32 v99, v99, v95
    v_exp_f32 v96, v96
    v_exp_f32 v97, v97
    s_waitcnt lgkmcnt(3)
    v_mfma_f32_32x32x16_bf16 v[48:63], v[64:67], v[240:243], v[48:63]
    s_barrier
    ds_read_b128 v[64:67], v3 offset:24576
    v_exp_f32 v98, v98
    v_exp_f32 v99, v99
    v_add_f32 v96, 1.0, v96
    v_add_f32 v97, 1.0, v97
    v_add_f32 v98, 1.0, v98
    v_add_f32 v99, 1.0, v99
    s_waitcnt lgkmcnt(3)
    v_mfma_f32_32x32x16_bf16 v[48:63], v[68:71], v[244:247], v[48:63]
    ds_read_b128 v[68:71], v3 offset:26624
    v_rcp_f32 v96, v96
    v_rcp_f32 v97, v97
    v_rcp_f32 v98, v98
    v_rcp_f32 v99, v99
    v_mul_f32 v92, v92, v96
    v_mul_f32 v93, v93, v97
    s_waitcnt lgkmcnt(3)
    v_mfma_f32_32x32x16_bf16 v[48:63], v[72:75], v[248:251], v[48:63]
    ds_read_b128 v[72:75], v3 offset:28672
    v_mul_f32 v94, v94, v98
    v_mul_f32 v95, v95, v99
    v_cvt_pk_bf16_f32 v90, v92, v93
    v_cvt_pk_bf16_f32 v91, v94, v95
    s_nop 0
    s_waitcnt lgkmcnt(3)
    v_mfma_f32_32x32x16_bf16 v[48:63], v[76:79], v[252:255], v[48:63]
    ds_read_b128 v[76:79], v3 offset:30720
    s_cmp_eq_u32 s41, 0
    s_cbranch_scc1 c_ds2104_s
    buffer_store_dwordx4 v[88:91], v1, s[24:27], s62 offen nt
    s_branch c_ds2104_e
c_ds2104_s:
    buffer_store_dwordx4 v[88:91], v1, s[24:27], s62 offen sc1
c_ds2104_e:
    s_waitcnt lgkmcnt(3)
    v_mfma_f32_32x32x16_bf16 v[32:47], v[64:67], v[128:131], 0
    s_barrier
    ds_read_b128 v[64:67], v3 offset:32768
    s_waitcnt lgkmcnt(3)
    v_mfma_f32_32x32x16_bf16 v[32:47], v[68:71], v[132:135], v[32:47]
    ds_read_b128 v[68:71], v3 offset:34816
    s_waitcnt lgkmcnt(3)
    v_mfma_f32_32x32x16_bf16 v[32:47], v[72:75], v[136:139], v[32:47]
    ds_read_b128 v[72:75], v3 offset:36864
    s_waitcnt lgkmcnt(3)
    v_mfma_f32_32x32x16_bf16 v[32:47], v[76:79], v[140:143], v[32:47]
    ds_read_b128 v[76:79], v3 offset:38912
    v_add_u32 v83, 155648, v13
    ds_read_b32 v80, v83 offset:0
    ds_read_b32 v81, v83 offset:256
    v_add_u32 v83, 155648, v12
    v_mov_b32 v82, 3184710632
    ds_read_b128 v[100:103], v83 offset:6656
    ds_read_b128 v[104:107], v83 offset:3840
    s_waitcnt lgkmcnt(7)
    v_mfma_f32_32x32x16_bf16 v[32:47], v[64:67], v[144:147], v[32:47]
    s_barrier
    ds_read_b128 v[64:67], v3 offset:40960
    s_waitcnt lgkmcnt(3)
    v_mul_f32 v80, v80, v81
    s_waitcnt lgkmcnt(1)
    v_fma_f32 v104, -v80, v100, v104
    v_mfma_f32_32x32x16_bf16 v[32:47], v[68:71], v[148:151], v[32:47]
    ds_read_b128 v[68:71], v3 offset:43008
    v_fma_f32 v105, -v80, v101, v105
    v_fma_f32 v106, -v80, v102, v106
    v_fma_f32 v107, -v80, v103, v107
    v_fma_f32 v92, v48, v81, v104
    v_fma_f32 v93, v49, v81, v105
    v_fma_f32 v94, v50, v81, v106
    v_fma_f32 v95, v51, v81, v107
    v_mfma_f32_32x32x16_bf16 v[32:47], v[72:75], v[152:155], v[32:47]
    ds_read_b128 v[72:75], v3 offset:45056
    ds_read_b128 v[108:111], v83 offset:6688
    ds_read_b128 v[112:115], v83 offset:3872
    v_mul_f32 v96, v92, v92
    v_mul_f32 v97, v93, v93
    v_mul_f32 v98, v94, v94
    v_mul_f32 v99, v95, v95
    v_fmaak_f32 v96, v96, v82, 3222493025
    v_mfma_f32_32x32x16_bf16 v[32:47], v[76:79], v[156:159], v[32:47]
    ds_read_b128 v[76:79], v3 offset:47104
    v_fmaak_f32 v97, v97, v82, 3222493025
    v_fmaak_f32 v98, v98, v82, 3222493025
    v_fmaak_f32 v99, v99, v82, 3222493025
    v_mul_f32 v96, v96, v92
    v_mul_f32 v97, v97, v93
    v_mul_f32 v98, v98, v94
    v_mul_f32 v99, v99, v95
    s_waitcnt lgkmcnt(5)
    v_mfma_f32_32x32x16_bf16 v[32:47], v[64:67], v[160:163], v[32:47]
    s_barrier
    ds_read_b128 v[64:67], v3 offset:49152
    v_exp_f32 v96, v96
    v_exp_f32 v97, v97
    v_exp_f32 v98, v98
    v_exp_f32 v99, v99
    v_add_f32 v96, 1.0, v96
    v_add_f32 v97, 1.0, v97
    v_add_f32 v98, 1.0, v98
    s_waitcnt lgkmcnt(5)
    v_mfma_f32_32x32x16_bf16 v[32:47], v[68:71], v[164:167], v[32:47]
    ds_read_b128 v[68:71], v3 offset:51200
    v_add_f32 v99, 1.0, v99
    v_rcp_f32 v96, v96
    v_rcp_f32 v97, v97
    v_rcp_f32 v98, v98
    v_rcp_f32 v99, v99
    v_mul_f32 v92, v92, v96
    v_mul_f32 v93, v93, v97
    s_waitcnt lgkmcnt(5)
    v_mfma_f32_32x32x16_bf16 v[32:47], v[72:75], v[168:171], v[32:47]
    ds_read_b128 v[72:75], v3 offset:53248
    v_mul_f32 v94, v94, v98
    v_mul_f32 v95, v95, v99
    v_cvt_pk_bf16_f32 v84, v92, v93
    v_cvt_pk_bf16_f32 v85, v94, v95
    s_waitcnt lgkmcnt(4)
    v_fma_f32 v112, -v80, v108, v112
    v_fma_f32 v113, -v80, v109, v113
    s_waitcnt lgkmcnt(3)
    v_mfma_f32_32x32x16_bf16 v[32:47], v[76:79], v[172:175], v[32:47]
    ds_read_b128 v[76:79], v3 offset:55296
    v_fma_f32 v114, -v80, v110, v114
    v_fma_f32 v115, -v80, v111, v115
    v_fma_f32 v92, v52, v81, v112
    v_fma_f32 v93, v53, v81, v113
    v_fma_f32 v94, v54, v81, v114
    v_fma_f32 v95, v55, v81, v115
    s_waitcnt lgkmcnt(3)
    v_mfma_f32_32x32x16_bf16 v[32:47], v[64:67], v[176:179], v[32:47]
    s_barrier
    ds_read_b128 v[64:67], v3 offset:57344
    ds_read_b128 v[100:103], v83 offset:6720
    ds_read_b128 v[104:107], v83 offset:3904
    v_mul_f32 v96, v92, v92
    v_mul_f32 v97, v93, v93
    v_mul_f32 v98, v94, v94
    v_mul_f32 v99, v95, v95
    s_waitcnt lgkmcnt(5)
    v_mfma_f32_32x32x16_bf16 v[32:47], v[68:71], v[180:183], v[32:47]
    ds_read_b128 v[68:71], v3 offset:59392
    v_fmaak_f32 v96, v96, v82, 3222493025
    v_fmaak_f32 v97, v97, v82, 3222493025
    v_fmaak_f32 v98, v98, v82, 3222493025
    v_fmaak_f32 v99, v99, v82, 3222493025
    v_mul_f32 v96, v96, v92
    v_mul_f32 v97, v97, v93
    s_waitcnt lgkmcnt(5)
    v_mfma_f32_32x32x16_bf16 v[32:47], v[72:75], v[184:187], v[32:47]
    ds_read_b128 v[72:75], v3 offset:61440
    v_mul_f32 v98, v98, v94
    v_mul_f32 v99, v99, v95
    v_exp_f32 v96, v96
    v_exp_f32 v97, v97
    v_exp_f32 v98, v98
    v_exp_f32 v99, v99
    s_waitcnt lgkmcnt(5)
    v_mfma_f32_32x32x16_bf16 v[32:47], v[76:79], v[188:191], v[32:47]
    ds_read_b128 v[76:79], v3 offset:63488
    v_add_f32 v96, 1.0, v96
    v_add_f32 v97, 1.0, v97
    v_add_f32 v98, 1.0, v98
    v_add_f32 v99, 1.0, v99
    v_rcp_f32 v96, v96
    v_rcp_f32 v97, v97
    s_waitcnt lgkmcnt(5)
    v_mfma_f32_32x32x16_bf16 v[32:47], v[64:67], v[192:195], v[32:47]
    s_barrier
    ds_read_b128 v[64:67], v4 offset:0
    v_rcp_f32 v98, v98
    v_rcp_f32 v99, v99
    v_mul_f32 v92, v92, v96
    v_mul_f32 v93, v93, v97
    v_mul_f32 v94, v94, v98
    v_mul_f32 v95, v95, v99
    s_waitcnt lgkmcnt(3)
    v_mfma_f32_32x32x16_bf16 v[32:47], v[68:71], v[196:199], v[32:47]
    ds_read_b128 v[68:71], v4 offset:2048
    v_cvt_pk_bf16_f32 v86, v92, v93
    v_cvt_pk_bf16_f32 v87, v94, v95
    s_nop 0
    v_fma_f32 v104, -v80, v100, v104
    v_fma_f32 v105, -v80, v101, v105
    s_waitcnt lgkmcnt(3)
    v_mfma_f32_32x32x16_bf16 v[32:47], v[72:75], v[200:203], v[32:47]
    ds_read_b128 v[72:75], v4 offset:4096
    v_fma_f32 v106, -v80, v102, v106
    v_fma_f32 v107, -v80, v103, v107
    v_fma_f32 v92, v56, v81, v104
    v_fma_f32 v93, v57, v81, v105
    v_fma_f32 v94, v58, v81, v106
    v_fma_f32 v95, v59, v81, v107
    s_waitcnt lgkmcnt(3)
    v_mfma_f32_32x32x16_bf16 v[32:47], v[76:79], v[204:207], v[32:47]
    ds_read_b128 v[76:79], v4 offset:6144
    ds_read_b128 v[108:111], v83 offset:6752
    ds_read_b128 v[112:115], v83 offset:3936
    v_mul_f32 v96, v92, v92
    v_mul_f32 v97, v93, v93
    v_mul_f32 v98, v94, v94
    v_mul_f32 v99, v95, v95
    s_cmp_eq_u32 s41, 0
    s_cbranch_scc1 c_ds2279_s
    buffer_store_dwordx4 v[84:87], v1, s[24:27], s63 offen nt
    s_branch c_ds2279_e
c_ds2279_s:
    buffer_store_dwordx4 v[84:87], v1, s[24:27], s63 offen sc1
c_ds2279_e:
    s_waitcnt lgkmcnt(5)
    v_mfma_f32_32x32x16_bf16 v[32:47], v[64:67], v[208:211], v[32:47]
    s_barrier
    ds_read_b128 v[64:67], v4 offset:8192
    v_fmaak_f32 v96, v96, v82, 3222493025
    v_fmaak_f32 v97, v97, v82, 3222493025
    v_fmaak_f32 v98, v98, v82, 3222493025
    v_fmaak_f32 v99, v99, v82, 3222493025
    v_mul_f32 v96, v96, v92
    v_mul_f32 v97, v97, v93
    s_waitcnt lgkmcnt(5)
    v_mfma_f32_32x32x16_bf16 v[32:47], v[68:71], v[212:215], v[32:47]
    ds_read_b128 v[68:71], v4 offset:10240
    v_mul_f32 v98, v98, v94
    v_mul_f32 v99, v99, v95
    v_exp_f32 v96, v96
    v_exp_f32 v97, v97
    v_exp_f32 v98, v98
    v_exp_f32 v99, v99
    s_waitcnt lgkmcnt(5)
    v_mfma_f32_32x32x16_bf16 v[32:47], v[72:75], v[216:219], v[32:47]
    ds_read_b128 v[72:75], v4 offset:12288
    v_add_f32 v96, 1.0, v96
    v_add_f32 v97, 1.0, v97
    v_add_f32 v98, 1.0, v98
    v_add_f32 v99, 1.0, v99
    v_rcp_f32 v96, v96
    v_rcp_f32 v97, v97
    s_waitcnt lgkmcnt(5)
    v_mfma_f32_32x32x16_bf16 v[32:47], v[76:79], v[220:223], v[32:47]
    ds_read_b128 v[76:79], v4 offset:14336
    v_rcp_f32 v98, v98
    v_rcp_f32 v99, v99
    v_mul_f32 v92, v92, v96
    v_mul_f32 v93, v93, v97
    v_mul_f32 v94, v94, v98
    v_mul_f32 v95, v95, v99
    s_waitcnt lgkmcnt(3)
    v_mfma_f32_32x32x16_bf16 v[32:47], v[64:67], v[224:227], v[32:47]
    s_barrier
    ds_read_b128 v[64:67], v4 offset:16384
    v_cvt_pk_bf16_f32 v88, v92, v93
    v_cvt_pk_bf16_f32 v89, v94, v95
    v_fma_f32 v112, -v80, v108, v112
    v_fma_f32 v113, -v80, v109, v113
    v_fma_f32 v114, -v80, v110, v114
    v_fma_f32 v115, -v80, v111, v115
    s_waitcnt lgkmcnt(3)
    v_mfma_f32_32x32x16_bf16 v[32:47], v[68:71], v[228:231], v[32:47]
    ds_read_b128 v[68:71], v4 offset:18432
    v_fma_f32 v92, v60, v81, v112
    v_fma_f32 v93, v61, v81, v113
    v_fma_f32 v94, v62, v81, v114
    v_fma_f32 v95, v63, v81, v115
    v_mul_f32 v96, v92, v92
    v_mul_f32 v97, v93, v93
    s_waitcnt lgkmcnt(3)
    v_mfma_f32_32x32x16_bf16 v[32:47], v[72:75], v[232:235], v[32:47]
    ds_read_b128 v[72:75], v4 offset:20480
    v_mul_f32 v98, v94, v94
    v_mul_f32 v99, v95, v95
    v_fmaak_f32 v96, v96, v82, 3222493025
    v_fmaak_f32 v97, v97, v82, 3222493025
    v_fmaak_f32 v98, v98, v82, 3222493025
    v_fmaak_f32 v99, v99, v82, 3222493025
    s_waitcnt lgkmcnt(3)
    v_mfma_f32_32x32x16_bf16 v[32:47], v[76:79], v[236:239], v[32:47]
    ds_read_b128 v[76:79], v4 offset:22528
    v_mul_f32 v96, v96, v92
    v_mul_f32 v97, v97, v93
    v_mul_f32 v98, v98, v94
    v_mul_f32 v99, v99, v95
    v_exp_f32 v96, v96
    v_exp_f32 v97, v97
    s_waitcnt lgkmcnt(3)
    v_mfma_f32_32x32x16_bf16 v[32:47], v[64:67], v[240:243], v[32:47]
    v_exp_f32 v98, v98
    v_exp_f32 v99, v99
    v_add_f32 v96, 1.0, v96
    v_add_f32 v97, 1.0, v97
    v_add_f32 v98, 1.0, v98
    v_add_f32 v99, 1.0, v99
    s_waitcnt lgkmcnt(2)
    v_mfma_f32_32x32x16_bf16 v[32:47], v[68:71], v[244:247], v[32:47]
    v_rcp_f32 v96, v96
    v_rcp_f32 v97, v97
    v_rcp_f32 v98, v98
    v_rcp_f32 v99, v99
    v_mul_f32 v92, v92, v96
    v_mul_f32 v93, v93, v97
    s_waitcnt lgkmcnt(1)
    v_mfma_f32_32x32x16_bf16 v[32:47], v[72:75], v[248:251], v[32:47]
    v_mul_f32 v94, v94, v98
    v_mul_f32 v95, v95, v99
    v_cvt_pk_bf16_f32 v90, v92, v93
    v_cvt_pk_bf16_f32 v91, v94, v95
    s_nop 0
    s_waitcnt lgkmcnt(0)
    v_mfma_f32_32x32x16_bf16 v[32:47], v[76:79], v[252:255], v[32:47]
    s_cmp_eq_u32 s41, 0
    s_cbranch_scc1 c_ds2385_s
    buffer_store_dwordx4 v[88:91], v1, s[24:27], s64 offen nt
    s_branch c_ds2385_e
c_ds2385_s:
    buffer_store_dwordx4 v[88:91], v1, s[24:27], s64 offen sc1
c_ds2385_e:
    s_nop 11
    s_barrier
    v_add_u32 v124, 155648, v13
    v_add_u32 v125, 155648, v12
    ds_read_b32 v80, v124 offset:0
    ds_read_b32 v82, v124 offset:256
    ds_read_b128 v[48:51], v125 offset:6912
    ds_read_b128 v[96:99], v125 offset:4096
    ds_read_b128 v[52:55], v125 offset:6944
    ds_read_b128 v[100:103], v125 offset:4128
    ds_read_b128 v[56:59], v125 offset:6976
    ds_read_b128 v[104:107], v125 offset:4160
    ds_read_b128 v[60:63], v125 offset:7008
    ds_read_b128 v[108:111], v125 offset:4192
    v_mov_b32 v120, 3184710632
    v_mov_b32 v122, 3222493025
    s_waitcnt lgkmcnt(8)
    v_mul_f32 v80, v80, v82
    v_sub_f32 v80, 0, v80
    s_waitcnt lgkmcnt(6)
    v_pk_fma_f32 v[96:97], v[48:49], v[80:81], v[96:97] op_sel_hi:[1,0,1]
    v_pk_fma_f32 v[98:99], v[50:51], v[80:81], v[98:99] op_sel_hi:[1,0,1]
    v_pk_fma_f32 v[112:113], v[32:33], v[82:83], v[96:97] op_sel_hi:[1,0,1]
    v_pk_fma_f32 v[114:115], v[34:35], v[82:83], v[98:99] op_sel_hi:[1,0,1]
    v_pk_mul_f32 v[116:117], v[112:113], v[112:113]
    v_pk_mul_f32 v[118:119], v[114:115], v[114:115]
    v_pk_fma_f32 v[116:117], v[116:117], v[120:121], v[122:123] op_sel_hi:[1,0,0]
    v_pk_fma_f32 v[118:119], v[118:119], v[120:121], v[122:123] op_sel_hi:[1,0,0]
    v_pk_mul_f32 v[116:117], v[116:117], v[112:113]
    v_pk_mul_f32 v[118:119], v[118:119], v[114:115]
    v_exp_f32 v116, v116
    v_exp_f32 v117, v117
    v_exp_f32 v118, v118
    v_exp_f32 v119, v119
    v_pk_add_f32 v[116:117], v[116:117], 1.0 op_sel_hi:[1,0]
    v_pk_add_f32 v[118:119], v[118:119], 1.0 op_sel_hi:[1,0]
    v_rcp_f32 v116, v116
    v_rcp_f32 v117, v117
    v_rcp_f32 v118, v118
    v_rcp_f32 v119, v119
    v_pk_mul_f32 v[112:113], v[112:113], v[116:117]
    v_pk_mul_f32 v[114:115], v[114:115], v[118:119]
    v_cvt_pk_bf16_f32 v84, v112, v113
    v_cvt_pk_bf16_f32 v85, v114, v115
    s_waitcnt lgkmcnt(4)
    v_pk_fma_f32 v[100:101], v[52:53], v[80:81], v[100:101] op_sel_hi:[1,0,1]
    v_pk_fma_f32 v[102:103], v[54:55], v[80:81], v[102:103] op_sel_hi:[1,0,1]
    v_pk_fma_f32 v[112:113], v[36:37], v[82:83], v[100:101] op_sel_hi:[1,0,1]
    v_pk_fma_f32 v[114:115], v[38:39], v[82:83], v[102:103] op_sel_hi:[1,0,1]
    v_pk_mul_f32 v[116:117], v[112:113], v[112:113]
    v_pk_mul_f32 v[118:119], v[114:115], v[114:115]
    v_pk_fma_f32 v[116:117], v[116:117], v[120:121], v[122:123] op_sel_hi:[1,0,0]
    v_pk_fma_f32 v[118:119], v[118:119], v[120:121], v[122:123] op_sel_hi:[1,0,0]
    v_pk_mul_f32 v[116:117], v[116:117], v[112:113]
    v_pk_mul_f32 v[118:119], v[118:119], v[114:115]
    v_exp_f32 v116, v116
    v_exp_f32 v117, v117
    v_exp_f32 v118, v118
    v_exp_f32 v119, v119
    v_pk_add_f32 v[116:117], v[116:117], 1.0 op_sel_hi:[1,0]
    v_pk_add_f32 v[118:119], v[118:119], 1.0 op_sel_hi:[1,0]
    v_rcp_f32 v116, v116
    v_rcp_f32 v117, v117
    v_rcp_f32 v118, v118
    v_rcp_f32 v119, v119
    v_pk_mul_f32 v[112:113], v[112:113], v[116:117]
    v_pk_mul_f32 v[114:115], v[114:115], v[118:119]
    v_cvt_pk_bf16_f32 v86, v112, v113
    v_cvt_pk_bf16_f32 v87, v114, v115
    s_nop 0
    s_cmp_eq_u32 s41, 0
    s_cbranch_scc1 c_ds2462_s
    buffer_store_dwordx4 v[84:87], v1, s[24:27], s65 offen nt
    s_branch c_ds2462_e
c_ds2462_s:
    buffer_store_dwordx4 v[84:87], v1, s[24:27], s65 offen sc1
c_ds2462_e:
    s_waitcnt lgkmcnt(2)
    v_pk_fma_f32 v[104:105], v[56:57], v[80:81], v[104:105] op_sel_hi:[1,0,1]
    v_pk_fma_f32 v[106:107], v[58:59], v[80:81], v[106:107] op_sel_hi:[1,0,1]
    v_pk_fma_f32 v[112:113], v[40:41], v[82:83], v[104:105] op_sel_hi:[1,0,1]
    v_pk_fma_f32 v[114:115], v[42:43], v[82:83], v[106:107] op_sel_hi:[1,0,1]
    v_pk_mul_f32 v[116:117], v[112:113], v[112:113]
    v_pk_mul_f32 v[118:119], v[114:115], v[114:115]
    v_pk_fma_f32 v[116:117], v[116:117], v[120:121], v[122:123] op_sel_hi:[1,0,0]
    v_pk_fma_f32 v[118:119], v[118:119], v[120:121], v[122:123] op_sel_hi:[1,0,0]
    v_pk_mul_f32 v[116:117], v[116:117], v[112:113]
    v_pk_mul_f32 v[118:119], v[118:119], v[114:115]
    v_exp_f32 v116, v116
    v_exp_f32 v117, v117
    v_exp_f32 v118, v118
    v_exp_f32 v119, v119
    v_pk_add_f32 v[116:117], v[116:117], 1.0 op_sel_hi:[1,0]
    v_pk_add_f32 v[118:119], v[118:119], 1.0 op_sel_hi:[1,0]
    v_rcp_f32 v116, v116
    v_rcp_f32 v117, v117
    v_rcp_f32 v118, v118
    v_rcp_f32 v119, v119
    v_pk_mul_f32 v[112:113], v[112:113], v[116:117]
    v_pk_mul_f32 v[114:115], v[114:115], v[118:119]
    v_cvt_pk_bf16_f32 v88, v112, v113
    v_cvt_pk_bf16_f32 v89, v114, v115
    s_waitcnt lgkmcnt(0)
    v_pk_fma_f32 v[108:109], v[60:61], v[80:81], v[108:109] op_sel_hi:[1,0,1]
    v_pk_fma_f32 v[110:111], v[62:63], v[80:81], v[110:111] op_sel_hi:[1,0,1]
    v_pk_fma_f32 v[112:113], v[44:45], v[82:83], v[108:109] op_sel_hi:[1,0,1]
    v_pk_fma_f32 v[114:115], v[46:47], v[82:83], v[110:111] op_sel_hi:[1,0,1]
    v_pk_mul_f32 v[116:117], v[112:113], v[112:113]
    v_pk_mul_f32 v[118:119], v[114:115], v[114:115]
    v_pk_fma_f32 v[116:117], v[116:117], v[120:121], v[122:123] op_sel_hi:[1,0,0]
    v_pk_fma_f32 v[118:119], v[118:119], v[120:121], v[122:123] op_sel_hi:[1,0,0]
    v_pk_mul_f32 v[116:117], v[116:117], v[112:113]
    v_pk_mul_f32 v[118:119], v[118:119], v[114:115]
    v_exp_f32 v116, v116
    v_exp_f32 v117, v117
    v_exp_f32 v118, v118
    v_exp_f32 v119, v119
    v_pk_add_f32 v[116:117], v[116:117], 1.0 op_sel_hi:[1,0]
    v_pk_add_f32 v[118:119], v[118:119], 1.0 op_sel_hi:[1,0]
    v_rcp_f32 v116, v116
    v_rcp_f32 v117, v117
    v_rcp_f32 v118, v118
    v_rcp_f32 v119, v119
    v_pk_mul_f32 v[112:113], v[112:113], v[116:117]
    v_pk_mul_f32 v[114:115], v[114:115], v[118:119]
    v_cvt_pk_bf16_f32 v90, v112, v113
    v_cvt_pk_bf16_f32 v91, v114, v115
    s_nop 0
    s_cmp_eq_u32 s41, 0
    s_cbranch_scc1 c_ds2520_s
    buffer_store_dwordx4 v[88:91], v1, s[24:27], s66 offen nt
    s_branch c_ds2520_e
c_ds2520_s:
    buffer_store_dwordx4 v[88:91], v1, s[24:27], s66 offen sc1
c_ds2520_e:
    s_lshl_b32 s50, s36, 7
    s_lshl_b32 s51, s37, 2
    s_add_u32 s51, s51, s50
    s_lshl_b32 s74, s40, 2
    s_add_u32 s74, s74, 3
    s_add_u32 s74, s74, s87
    v_mov_b32 v81, s51
    v_mov_b32 v83, s74
    v_and_b32 v82, 7, v0
    v_lshlrev_b32 v82, 2, v82
    v_add_u32 v82, s50, v82
    s_mov_b32 s60, 400000
    s_waitcnt vmcnt(0) lgkmcnt(0)
    s_barrier
    s_cmp_lg_u32 s38, 0
    s_cbranch_scc1 L_p4h_skip
    s_mov_b64 exec, 1
    s_cmp_eq_u32 s41, 0
    s_cbranch_scc1 L_p4h_sl
    buffer_store_dword v83, v81, s[24:27], 0 offen
    s_branch L_p4h_st
L_p4h_sl:
    buffer_store_dword v83, v81, s[24:27], 0 offen sc1
L_p4h_st:
    s_mov_b64 exec, -1
L_p4h_p:
    buffer_load_dword v80, v82, s[24:27], 0 offen sc1
    s_waitcnt vmcnt(0)
    v_subrev_u32 v80, s74, v80
    v_cmp_le_u32 vcc, 8, v80
    s_sub_u32 s60, s60, 1
    s_cbranch_scc1 L_p4h_p_x
    s_cbranch_vccnz L_p4h_p
L_p4h_p_x:
L_p4h_skip:
    s_barrier
    s_mul_i32 s51, s42, 88064
    s_add_u32 s51, s51, s54
    s_lshl_b32 s52, s43, 10
    s_add_u32 s51, s51, s52
    s_add_u32 s50, s51, 0
    buffer_load_dwordx4 v[128:131], v1, s[24:27], s50 offen sc1
    s_add_u32 s50, s51, 2048
    buffer_load_dwordx4 v[132:135], v1, s[24:27], s50 offen sc1
    s_add_u32 s50, s51, 4096
    buffer_load_dwordx4 v[136:139], v1, s[24:27], s50 offen sc1
    s_add_u32 s50, s51, 6144
    buffer_load_dwordx4 v[140:143], v1, s[24:27], s50 offen sc1
    s_add_u32 s50, s51, 8192
    buffer_load_dwordx4 v[144:147], v1, s[24:27], s50 offen sc1
    s_add_u32 s50, s51, 10240
    buffer_load_dwordx4 v[148:151], v1, s[24:27], s50 offen sc1
    s_add_u32 s50, s51, 12288
    buffer_load_dwordx4 v[152:155], v1, s[24:27], s50 offen sc1
    s_add_u32 s50, s51, 14336
    buffer_load_dwordx4 v[156:159], v1, s[24:27], s50 offen sc1
    s_add_u32 s50, s51, 16384
    buffer_load_dwordx4 v[160:163], v1, s[24:27], s50 offen sc1
    s_add_u32 s50, s51, 18432
    buffer_load_dwordx4 v[164:167], v1, s[24:27], s50 offen sc1
    s_add_u32 s50, s51, 20480
    buffer_load_dwordx4 v[168:171], v1, s[24:27], s50 offen sc1
    s_add_u32 s50, s51, 22528
    buffer_load_dwordx4 v[172:175], v1, s[24:27], s50 offen sc1
    s_barrier
    ds_read_b128 v[64:67], v5 offset:40960
    ds_read_b128 v[68:71], v8 offset:40960
    ds_read_b128 v[72:75], v5 offset:45056
    ds_read_b128 v[76:79], v8 offset:45056
    s_waitcnt vmcnt(11)
    s_waitcnt lgkmcnt(2)
    v_mfma_f32_32x32x16_bf16 v[32:47], v[64:67], v[128:131], 0
    ds_read_b128 v[80:83], v5 offset:49152
    ds_read_b128 v[84:87], v8 offset:49152
    v_mfma_f32_32x32x16_bf16 v[48:63], v[68:71], v[128:131], 0
    s_add_u32 s50, s51, 24576
    buffer_load_dwordx4 v[128:131], v1, s[24:27], s50 offen sc1
    s_waitcnt vmcnt(11)
    s_waitcnt lgkmcnt(2)
    v_mfma_f32_32x32x16_bf16 v[32:47], v[72:75], v[132:135], v[32:47]
    ds_read_b128 v[64:67], v5 offset:53248
    ds_read_b128 v[68:71], v8 offset:53248
    v_mfma_f32_32x32x16_bf16 v[48:63], v[76:79], v[132:135], v[48:63]
    s_add_u32 s50, s51, 26624
    buffer_load_dwordx4 v[132:135], v1, s[24:27], s50 offen sc1
    s_waitcnt vmcnt(11)
    s_waitcnt lgkmcnt(2)
    v_mfma_f32_32x32x16_bf16 v[32:47], v[80:83], v[136:139], v[32:47]
    s_barrier
    ds_read_b128 v[72:75], v5 offset:57344
    ds_read_b128 v[76:79], v8 offset:57344
    v_mfma_f32_32x32x16_bf16 v[48:63], v[84:87], v[136:139], v[48:63]
    s_add_u32 s50, s51, 28672
    buffer_load_dwordx4 v[136:139], v1, s[24:27], s50 offen sc1
    s_waitcnt vmcnt(11)
    s_waitcnt lgkmcnt(2)
    v_mfma_f32_32x32x16_bf16 v[32:47], v[64:67], v[140:143], v[32:47]
    ds_read_b128 v[80:83], v5 offset:61440
    ds_read_b128 v[84:87], v8 offset:61440
    v_mfma_f32_32x32x16_bf16 v[48:63], v[68:71], v[140:143], v[48:63]
    s_add_u32 s50, s51, 30720
    buffer_load_dwordx4 v[140:143], v1, s[24:27], s50 offen sc1
    s_waitcnt vmcnt(11)
    s_waitcnt lgkmcnt(2)
    v_mfma_f32_32x32x16_bf16 v[32:47], v[72:75], v[144:147], v[32:47]
    ds_read_b128 v[64:67], v6 offset:0
    ds_read_b128 v[68:71], v9 offset:0
    v_mfma_f32_32x32x16_bf16 v[48:63], v[76:79], v[144:147], v[48:63]
    s_add_u32 s50, s51, 32768
    buffer_load_dwordx4 v[144:147], v1, s[24:27], s50 offen sc1
    s_waitcnt vmcnt(11)
    s_waitcnt lgkmcnt(2)
    v_mfma_f32_32x32x16_bf16 v[32:47], v[80:83], v[148:151], v[32:47]
    ds_read_b128 v[72:75], v6 offset:4096
    ds_read_b128 v[76:79], v9 offset:4096
    v_mfma_f32_32x32x16_bf16 v[48:63], v[84:87], v[148:151], v[48:63]
    s_add_u32 s50, s51, 34816
    buffer_load_dwordx4 v[148:151], v1, s[24:27], s50 offen sc1
    s_waitcnt vmcnt(11)
    s_waitcnt lgkmcnt(2)
    v_mfma_f32_32x32x16_bf16 v[32:47], v[64:67], v[152:155], v[32:47]
    s_barrier
    ds_read_b128 v[80:83], v6 offset:8192
    ds_read_b128 v[84:87], v9 offset:8192
    v_mfma_f32_32x32x16_bf16 v[48:63], v[68:71], v[152:155], v[48:63]
    s_add_u32 s50, s51, 36864
    buffer_load_dwordx4 v[152:155], v1, s[24:27], s50 offen sc1
    s_waitcnt vmcnt(11)
    s_waitcnt lgkmcnt(2)
    v_mfma_f32_32x32x16_bf16 v[32:47], v[72:75], v[156:159], v[32:47]
    ds_read_b128 v[64:67], v6 offset:12288
    ds_read_b128 v[68:71], v9 offset:12288
    v_mfma_f32_32x32x16_bf16 v[48:63], v[76:79], v[156:159], v[48:63]
    s_add_u32 s50, s51, 38912
    buffer_load_dwordx4 v[156:159], v1, s[24:27], s50 offen sc1
    s_waitcnt vmcnt(11)
    s_waitcnt lgkmcnt(2)
    v_mfma_f32_32x32x16_bf16 v[32:47], v[80:83], v[160:163], v[32:47]
    ds_read_b128 v[72:75], v6 offset:16384
    ds_read_b128 v[76:79], v9 offset:16384
    v_mfma_f32_32x32x16_bf16 v[48:63], v[84:87], v[160:163], v[48:63]
    s_add_u32 s50, s51, 40960
    buffer_load_dwordx4 v[160:163], v1, s[24:27], s50 offen sc1
    s_waitcnt vmcnt(11)
    s_waitcnt lgkmcnt(2)
    v_mfma_f32_32x32x16_bf16 v[32:47], v[64:67], v[164:167], v[32:47]
    ds_read_b128 v[80:83], v6 offset:20480
    ds_read_b128 v[84:87], v9 offset:20480
    v_mfma_f32_32x32x16_bf16 v[48:63], v[68:71], v[164:167], v[48:63]
    s_add_u32 s50, s51, 43008
    buffer_load_dwordx4 v[164:167], v1, s[24:27], s50 offen sc1
    s_waitcnt vmcnt(11)
    s_waitcnt lgkmcnt(2)
    v_mfma_f32_32x32x16_bf16 v[32:47], v[72:75], v[168:171], v[32:47]
    s_barrier
    ds_read_b128 v[64:67], v5 offset:0
    ds_read_b128 v[68:71], v8 offset:0
    v_mfma_f32_32x32x16_bf16 v[48:63], v[76:79], v[168:171], v[48:63]
    s_add_u32 s50, s51, 45056
    buffer_load_dwordx4 v[168:171], v1, s[24:27], s50 offen sc1
    s_waitcnt vmcnt(11)
    s_waitcnt lgkmcnt(2)
    v_mfma_f32_32x32x16_bf16 v[32:47], v[80:83], v[172:175], v[32:47]
    ds_read_b128 v[72:75], v5 offset:4096
    ds_read_b128 v[76:79], v8 offset:4096
    v_mfma_f32_32x32x16_bf16 v[48:63], v[84:87], v[172:175], v[48:63]
    s_add_u32 s50, s51, 47104
    buffer_load_dwordx4 v[172:175], v1, s[24:27], s50 offen sc1
    s_waitcnt vmcnt(11)
    s_waitcnt lgkmcnt(2)
    v_mfma_f32_32x32x16_bf16 v[32:47], v[64:67], v[128:131], v[32:47]
    ds_read_b128 v[80:83], v5 offset:8192
    ds_read_b128 v[84:87], v8 offset:8192
    v_mfma_f32_32x32x16_bf16 v[48:63], v[68:71], v[128:131], v[48:63]
    s_add_u32 s50, s51, 49152
    buffer_load_dwordx4 v[128:131], v1, s[24:27], s50 offen sc1
    s_waitcnt vmcnt(11)
    s_waitcnt lgkmcnt(2)
    v_mfma_f32_32x32x16_bf16 v[32:47], v[72:75], v[132:135], v[32:47]
    ds_read_b128 v[64:67], v5 offset:12288
    ds_read_b128 v[68:71], v8 offset:12288
    v_mfma_f32_32x32x16_bf16 v[48:63], v[76:79], v[132:135], v[48:63]
    s_add_u32 s50, s51, 51200
    buffer_load_dwordx4 v[132:135], v1, s[24:27], s50 offen sc1
    s_waitcnt vmcnt(11)
    s_waitcnt lgkmcnt(2)
    v_mfma_f32_32x32x16_bf16 v[32:47], v[80:83], v[136:139], v[32:47]
    s_barrier
    ds_read_b128 v[72:75], v5 offset:16384
    ds_read_b128 v[76:79], v8 offset:16384
    v_mfma_f32_32x32x16_bf16 v[48:63], v[84:87], v[136:139], v[48:63]
    s_add_u32 s50, s51, 53248
    buffer_load_dwordx4 v[136:139], v1, s[24:27], s50 offen sc1
    s_waitcnt vmcnt(11)
    s_waitcnt lgkmcnt(2)
    v_mfma_f32_32x32x16_bf16 v[32:47], v[64:67], v[140:143], v[32:47]
    ds_read_b128 v[80:83], v5 offset:20480
    ds_read_b128 v[84:87], v8 offset:20480
    v_mfma_f32_32x32x16_bf16 v[48:63], v[68:71], v[140:143], v[48:63]
    s_add_u32 s50, s51, 55296
    buffer_load_dwordx4 v[140:143], v1, s[24:27], s50 offen sc1
    s_waitcnt vmcnt(11)
    s_waitcnt lgkmcnt(2)
    v_mfma_f32_32x32x16_bf16 v[32:47], v[72:75], v[144:147], v[32:47]
    ds_read_b128 v[64:67], v5 offset:24576
    ds_read_b128 v[68:71], v8 offset:24576
    v_mfma_f32_32x32x16_bf16 v[48:63], v[76:79], v[144:147], v[48:63]
    s_add_u32 s50, s51, 57344
    buffer_load_dwordx4 v[144:147], v1, s[24:27], s50 offen sc1
    s_waitcnt vmcnt(11)
    s_waitcnt lgkmcnt(2)
    v_mfma_f32_32x32x16_bf16 v[32:47], v[80:83], v[148:151], v[32:47]
    ds_read_b128 v[72:75], v5 offset:28672
    ds_read_b128 v[76:79], v8 offset:28672
    v_mfma_f32_32x32x16_bf16 v[48:63], v[84:87], v[148:151], v[48:63]
    s_add_u32 s50, s51, 59392
    buffer_load_dwordx4 v[148:151], v1, s[24:27], s50 offen sc1
    s_waitcnt vmcnt(11)
    s_waitcnt lgkmcnt(2)
    v_mfma_f32_32x32x16_bf16 v[32:47], v[64:67], v[152:155], v[32:47]
    s_barrier
    ds_read_b128 v[80:83], v5 offset:32768
    ds_read_b128 v[84:87], v8 offset:32768
    v_mfma_f32_32x32x16_bf16 v[48:63], v[68:71], v[152:155], v[48:63]
    s_add_u32 s50, s51, 61440
    buffer_load_dwordx4 v[152:155], v1, s[24:27], s50 offen sc1
    s_waitcnt vmcnt(11)
    s_waitcnt lgkmcnt(2)
    v_mfma_f32_32x32x16_bf16 v[32:47], v[72:75], v[156:159], v[32:47]
    ds_read_b128 v[64:67], v5 offset:36864
    ds_read_b128 v[68:71], v8 offset:36864
    v_mfma_f32_32x32x16_bf16 v[48:63], v[76:79], v[156:159], v[48:63]
    s_add_u32 s50, s51, 63488
    buffer_load_dwordx4 v[156:159], v1, s[24:27], s50 offen sc1
    s_waitcnt vmcnt(11)
    s_waitcnt lgkmcnt(2)
    v_mfma_f32_32x32x16_bf16 v[32:47], v[80:83], v[160:163], v[32:47]
    ds_read_b128 v[72:75], v6 offset:24576
    ds_read_b128 v[76:79], v9 offset:24576
    v_mfma_f32_32x32x16_bf16 v[48:63], v[84:87], v[160:163], v[48:63]
    s_add_u32 s50, s51, 65536
    buffer_load_dwordx4 v[160:163], v1, s[24:27], s50 offen sc1
    s_waitcnt vmcnt(11)
    s_waitcnt lgkmcnt(2)
    v_mfma_f32_32x32x16_bf16 v[32:47], v[64:67], v[164:167], v[32:47]
    ds_read_b128 v[80:83], v6 offset:28672
    ds_read_b128 v[84:87], v9 offset:28672
    v_mfma_f32_32x32x16_bf16 v[48:63], v[68:71], v[164:167], v[48:63]
    s_add_u32 s50, s51, 67584
    buffer_load_dwordx4 v[164:167], v1, s[24:27], s50 offen sc1
    s_waitcnt vmcnt(11)
    s_waitcnt lgkmcnt(2)
    v_mfma_f32_32x32x16_bf16 v[32:47], v[72:75], v[168:171], v[32:47]
    s_barrier
    ds_read_b128 v[64:67], v6 offset:32768
    ds_read_b128 v[68:71], v9 offset:32768
    v_mfma_f32_32x32x16_bf16 v[48:63], v[76:79], v[168:171], v[48:63]
    s_add_u32 s50, s51, 69632
    buffer_load_dwordx4 v[168:171], v1, s[24:27], s50 offen sc1
    s_waitcnt vmcnt(11)
    s_waitcnt lgkmcnt(2)
    v_mfma_f32_32x32x16_bf16 v[32:47], v[80:83], v[172:175], v[32:47]
    ds_read_b128 v[72:75], v6 offset:36864
    ds_read_b128 v[76:79], v9 offset:36864
    v_mfma_f32_32x32x16_bf16 v[48:63], v[84:87], v[172:175], v[48:63]
    s_add_u32 s50, s51, 71680
    buffer_load_dwordx4 v[172:175], v1, s[24:27], s50 offen sc1
    s_waitcnt vmcnt(11)
    s_waitcnt lgkmcnt(2)
    v_mfma_f32_32x32x16_bf16 v[32:47], v[64:67], v[128:131], v[32:47]
    ds_read_b128 v[80:83], v6 offset:40960
    ds_read_b128 v[84:87], v9 offset:40960
    v_mfma_f32_32x32x16_bf16 v[48:63], v[68:71], v[128:131], v[48:63]
    s_add_u32 s50, s51, 73728
    buffer_load_dwordx4 v[128:131], v1, s[24:27], s50 offen sc1
    s_waitcnt vmcnt(11)
    s_waitcnt lgkmcnt(2)
    v_mfma_f32_32x32x16_bf16 v[32:47], v[72:75], v[132:135], v[32:47]
    ds_read_b128 v[64:67], v6 offset:45056
    ds_read_b128 v[68:71], v9 offset:45056
    v_mfma_f32_32x32x16_bf16 v[48:63], v[76:79], v[132:135], v[48:63]
    s_add_u32 s50, s51, 75776
    buffer_load_dwordx4 v[132:135], v1, s[24:27], s50 offen sc1
    s_waitcnt vmcnt(11)
    s_waitcnt lgkmcnt(2)
    v_mfma_f32_32x32x16_bf16 v[32:47], v[80:83], v[136:139], v[32:47]
    s_barrier
    ds_read_b128 v[72:75], v6 offset:49152
    ds_read_b128 v[76:79], v9 offset:49152
    v_mfma_f32_32x32x16_bf16 v[48:63], v[84:87], v[136:139], v[48:63]
    s_add_u32 s50, s51, 77824
    buffer_load_dwordx4 v[136:139], v1, s[24:27], s50 offen sc1
    s_waitcnt vmcnt(11)
    s_waitcnt lgkmcnt(2)
    v_mfma_f32_32x32x16_bf16 v[32:47], v[64:67], v[140:143], v[32:47]
    ds_read_b128 v[80:83], v6 offset:53248
    ds_read_b128 v[84:87], v9 offset:53248
    v_mfma_f32_32x32x16_bf16 v[48:63], v[68:71], v[140:143], v[48:63]
    s_add_u32 s50, s51, 79872
    buffer_load_dwordx4 v[140:143], v1, s[24:27], s50 offen sc1
    s_waitcnt vmcnt(11)
    s_waitcnt lgkmcnt(2)
    v_mfma_f32_32x32x16_bf16 v[32:47], v[72:75], v[144:147], v[32:47]
    ds_read_b128 v[64:67], v6 offset:57344
    ds_read_b128 v[68:71], v9 offset:57344
    v_mfma_f32_32x32x16_bf16 v[48:63], v[76:79], v[144:147], v[48:63]
    s_add_u32 s50, s51, 81920
    buffer_load_dwordx4 v[144:147], v1, s[24:27], s50 offen sc1
    s_waitcnt vmcnt(11)
    s_waitcnt lgkmcnt(2)
    v_mfma_f32_32x32x16_bf16 v[32:47], v[80:83], v[148:151], v[32:47]
    ds_read_b128 v[72:75], v6 offset:61440
    ds_read_b128 v[76:79], v9 offset:61440
    v_mfma_f32_32x32x16_bf16 v[48:63], v[84:87], v[148:151], v[48:63]
    s_add_u32 s50, s51, 83968
    buffer_load_dwordx4 v[148:151], v1, s[24:27], s50 offen sc1
    s_waitcnt vmcnt(11)
    s_waitcnt lgkmcnt(2)
    v_mfma_f32_32x32x16_bf16 v[32:47], v[64:67], v[152:155], v[32:47]
    s_barrier
    ds_read_b128 v[80:83], v7 offset:0
    ds_read_b128 v[84:87], v10 offset:0
    v_mfma_f32_32x32x16_bf16 v[48:63], v[68:71], v[152:155], v[48:63]
    s_add_u32 s50, s51, 86016
    buffer_load_dwordx4 v[152:155], v1, s[24:27], s50 offen sc1
    s_waitcnt vmcnt(11)
    s_waitcnt lgkmcnt(2)
    v_mfma_f32_32x32x16_bf16 v[32:47], v[72:75], v[156:159], v[32:47]
    ds_read_b128 v[64:67], v7 offset:4096
    ds_read_b128 v[68:71], v10 offset:4096
    v_mfma_f32_32x32x16_bf16 v[48:63], v[76:79], v[156:159], v[48:63]
    s_waitcnt vmcnt(10)
    s_waitcnt lgkmcnt(2)
    v_mfma_f32_32x32x16_bf16 v[32:47], v[80:83], v[160:163], v[32:47]
    ds_read_b128 v[72:75], v7 offset:8192
    ds_read_b128 v[76:79], v10 offset:8192
    v_mfma_f32_32x32x16_bf16 v[48:63], v[84:87], v[160:163], v[48:63]
    s_waitcnt vmcnt(9)
    s_waitcnt lgkmcnt(2)
    v_mfma_f32_32x32x16_bf16 v[32:47], v[64:67], v[164:167], v[32:47]
    ds_read_b128 v[80:83], v7 offset:12288
    ds_read_b128 v[84:87], v10 offset:12288
    v_mfma_f32_32x32x16_bf16 v[48:63], v[68:71], v[164:167], v[48:63]
    s_waitcnt vmcnt(8)
    s_waitcnt lgkmcnt(2)
    v_mfma_f32_32x32x16_bf16 v[32:47], v[72:75], v[168:171], v[32:47]
    s_barrier
    ds_read_b128 v[64:67], v7 offset:16384
    ds_read_b128 v[68:71], v10 offset:16384
    v_mfma_f32_32x32x16_bf16 v[48:63], v[76:79], v[168:171], v[48:63]
    s_waitcnt vmcnt(7)
    s_waitcnt lgkmcnt(2)
    v_mfma_f32_32x32x16_bf16 v[32:47], v[80:83], v[172:175], v[32:47]
    ds_read_b128 v[72:75], v7 offset:20480
    ds_read_b128 v[76:79], v10 offset:20480
    v_mfma_f32_32x32x16_bf16 v[48:63], v[84:87], v[172:175], v[48:63]
    s_waitcnt vmcnt(6)
    s_waitcnt lgkmcnt(2)
    v_mfma_f32_32x32x16_bf16 v[32:47], v[64:67], v[128:131], v[32:47]
    ds_read_b128 v[80:83], v5 offset:40960
    ds_read_b128 v[84:87], v8 offset:40960
    v_mfma_f32_32x32x16_bf16 v[48:63], v[68:71], v[128:131], v[48:63]
    s_waitcnt vmcnt(5)
    s_waitcnt lgkmcnt(2)
    v_mfma_f32_32x32x16_bf16 v[32:47], v[72:75], v[132:135], v[32:47]
    ds_read_b128 v[64:67], v5 offset:45056
    ds_read_b128 v[68:71], v8 offset:45056
    v_mfma_f32_32x32x16_bf16 v[48:63], v[76:79], v[132:135], v[48:63]
    s_waitcnt vmcnt(4)
    s_waitcnt lgkmcnt(2)
    v_mfma_f32_32x32x16_bf16 v[32:47], v[80:83], v[136:139], v[32:47]
    s_barrier
    ds_read_b128 v[72:75], v5 offset:49152
    ds_read_b128 v[76:79], v8 offset:49152
    v_mfma_f32_32x32x16_bf16 v[48:63], v[84:87], v[136:139], v[48:63]
    s_waitcnt vmcnt(3)
    s_waitcnt lgkmcnt(2)
    v_mfma_f32_32x32x16_bf16 v[32:47], v[64:67], v[140:143], v[32:47]
    ds_read_b128 v[80:83], v5 offset:53248
    ds_read_b128 v[84:87], v8 offset:53248
    v_mfma_f32_32x32x16_bf16 v[48:63], v[68:71], v[140:143], v[48:63]
    s_waitcnt vmcnt(2)
    s_waitcnt lgkmcnt(2)
    v_mfma_f32_32x32x16_bf16 v[32:47], v[72:75], v[144:147], v[32:47]
    ds_read_b128 v[64:67], v5 offset:57344
    ds_read_b128 v[68:71], v8 offset:57344
    v_mfma_f32_32x32x16_bf16 v[48:63], v[76:79], v[144:147], v[48:63]
    s_waitcnt vmcnt(1)
    s_waitcnt lgkmcnt(2)
    v_mfma_f32_32x32x16_bf16 v[32:47], v[80:83], v[148:151], v[32:47]
    v_mfma_f32_32x32x16_bf16 v[48:63], v[84:87], v[148:151], v[48:63]
    s_waitcnt vmcnt(0)
    s_waitcnt lgkmcnt(0)
    v_mfma_f32_32x32x16_bf16 v[32:47], v[64:67], v[152:155], v[32:47]
    v_mfma_f32_32x32x16_bf16 v[48:63], v[68:71], v[152:155], v[48:63]
    s_cmp_lg_u32 s40, 0
    s_cbranch_scc1 L_c_final
    s_lshl_b32 s50, s38, 12
    s_add_u32 s50, s50, 0
    v_add_u32 v96, s50, v1
    s_xor_b32 s51, s38, 1
    s_lshl_b32 s51, s51, 12
    s_add_u32 s51, s51, 0
    v_add_u32 v97, s51, v1
    v_add_u32 v98, 155648, v12
    ds_read_b128 v[100:103], v98 offset:4352
    ds_read_b128 v[104:107], v98 offset:4384
    ds_read_b128 v[108:111], v98 offset:4416
    ds_read_b128 v[112:115], v98 offset:4448
    s_nop 7
    ds_write_b128 v96, v[48:51] offset:0
    ds_write_b128 v96, v[52:55] offset:1024
    ds_write_b128 v96, v[56:59] offset:2048
    ds_write_b128 v96, v[60:63] offset:3072
    s_waitcnt lgkmcnt(0)
    s_barrier
    ds_read_b128 v[80:83], v97 offset:0
    ds_read_b128 v[84:87], v97 offset:1024
    ds_read_b128 v[88:91], v97 offset:2048
    ds_read_b128 v[92:95], v97 offset:3072
    v_pk_add_f32 v[16:17], v[16:17], v[32:33]
    v_pk_add_f32 v[18:19], v[18:19], v[34:35]
    v_pk_add_f32 v[20:21], v[20:21], v[36:37]
    v_pk_add_f32 v[22:23], v[22:23], v[38:39]
    v_pk_add_f32 v[24:25], v[24:25], v[40:41]
    v_pk_add_f32 v[26:27], v[26:27], v[42:43]
    v_pk_add_f32 v[28:29], v[28:29], v[44:45]
    v_pk_add_f32 v[30:31], v[30:31], v[46:47]
    v_pk_add_f32 v[16:17], v[16:17], v[100:101]
    v_pk_add_f32 v[18:19], v[18:19], v[102:103]
    v_pk_add_f32 v[20:21], v[20:21], v[104:105]
    v_pk_add_f32 v[22:23], v[22:23], v[106:107]
    v_pk_add_f32 v[24:25], v[24:25], v[108:109]
    v_pk_add_f32 v[26:27], v[26:27], v[110:111]
    v_pk_add_f32 v[28:29], v[28:29], v[112:113]
    v_pk_add_f32 v[30:31], v[30:31], v[114:115]
    s_waitcnt lgkmcnt(0)
    v_pk_add_f32 v[16:17], v[16:17], v[80:81]
    v_pk_add_f32 v[18:19], v[18:19], v[82:83]
    v_pk_add_f32 v[20:21], v[20:21], v[84:85]
    v_pk_add_f32 v[22:23], v[22:23], v[86:87]
    v_pk_add_f32 v[24:25], v[24:25], v[88:89]
    v_pk_add_f32 v[26:27], v[26:27], v[90:91]
    v_pk_add_f32 v[28:29], v[28:29], v[92:93]
    v_pk_add_f32 v[30:31], v[30:31], v[94:95]
    v_cvt_pk_bf16_f32 v116, v16, v17
    v_cvt_pk_bf16_f32 v117, v18, v19
    v_cvt_pk_bf16_f32 v118, v20, v21
    v_cvt_pk_bf16_f32 v119, v22, v23
    v_cvt_pk_bf16_f32 v120, v24, v25
    v_cvt_pk_bf16_f32 v121, v26, v27
    v_cvt_pk_bf16_f32 v122, v28, v29
    v_cvt_pk_bf16_f32 v123, v30, v31
    s_cmp_eq_u32 s41, 0
    s_cbranch_scc1 c_ds2980_s
    buffer_store_dwordx4 v[116:119], v1, s[24:27], s53 offen nt
    s_branch c_ds2980_e
c_ds2980_s:
    buffer_store_dwordx4 v[116:119], v1, s[24:27], s53 offen sc1
c_ds2980_e:
    s_cmp_eq_u32 s41, 0
    s_cbranch_scc1 c_ds2987_s
    buffer_store_dwordx4 v[120:123], v1, s[24:27], s53 offen offset:1024 nt
    s_branch c_ds2987_e
c_ds2987_s:
    buffer_store_dwordx4 v[120:123], v1, s[24:27], s53 offen offset:1024 sc1
c_ds2987_e:
    v_pk_add_f32 v[100:101], v[16:17], v[18:19]
    v_pk_mul_f32 v[102:103], v[16:17], v[16:17]
    v_pk_fma_f32 v[102:103], v[18:19], v[18:19], v[102:103]
    v_pk_add_f32 v[100:101], v[100:101], v[20:21]
    v_pk_fma_f32 v[102:103], v[20:21], v[20:21], v[102:103]
    v_pk_add_f32 v[100:101], v[100:101], v[22:23]
    v_pk_fma_f32 v[102:103], v[22:23], v[22:23], v[102:103]
    v_pk_add_f32 v[100:101], v[100:101], v[24:25]
    v_pk_fma_f32 v[102:103], v[24:25], v[24:25], v[102:103]
    v_pk_add_f32 v[100:101], v[100:101], v[26:27]
    v_pk_fma_f32 v[102:103], v[26:27], v[26:27], v[102:103]
    v_pk_add_f32 v[100:101], v[100:101], v[28:29]
    v_pk_fma_f32 v[102:103], v[28:29], v[28:29], v[102:103]
    v_pk_add_f32 v[100:101], v[100:101], v[30:31]
    v_pk_fma_f32 v[102:103], v[30:31], v[30:31], v[102:103]
    v_add_f32 v100, v100, v101
    v_add_f32 v102, v102, v103
    s_lshl_b32 s50, s37, 1
    s_add_u32 s50, s50, s43
    s_lshr_b32 s51, s50, 2
    s_lshl_b32 s51, s51, 10
    s_and_b32 s50, s50, 3
    s_lshl_b32 s50, s50, 2
    s_add_u32 s50, s50, s51
    s_lshl_b32 s51, s42, 12
    s_add_u32 s50, s50, s51
    s_add_u32 s50, s50, s59
    v_permlane32_swap_b32 v100, v102
    v_add_f32 v100, v100, v102
    s_nop 0
    s_cmp_eq_u32 s41, 0
    s_cbranch_scc1 c_ds3024_s
    buffer_store_dword v100, v1, s[24:27], s50 offen nt
    s_branch c_ds3024_e
c_ds3024_s:
    buffer_store_dword v100, v1, s[24:27], s50 offen sc1
c_ds3024_e:
    s_lshl_b32 s50, s36, 7
    s_lshl_b32 s51, s37, 2
    s_add_u32 s51, s51, s50
    s_lshl_b32 s74, s40, 2
    s_add_u32 s74, s74, 4
    s_add_u32 s74, s74, s87
    v_mov_b32 v81, s51
    v_mov_b32 v83, s74
    v_and_b32 v82, 7, v0
    v_lshlrev_b32 v82, 2, v82
    v_add_u32 v82, s50, v82
    s_mov_b32 s60, 400000
    s_waitcnt vmcnt(0) lgkmcnt(0)
    s_barrier
    s_cmp_lg_u32 s38, 0
    s_cbranch_scc1 L_x2_skip
    s_mov_b64 exec, 1
    s_cmp_eq_u32 s41, 0
    s_cbranch_scc1 L_x2_sl
    buffer_store_dword v83, v81, s[24:27], 0 offen
    s_branch L_x2_st
L_x2_sl:
    buffer_store_dword v83, v81, s[24:27], 0 offen sc1
L_x2_st:
    s_mov_b64 exec, -1
L_x2_p:
    buffer_load_dword v80, v82, s[24:27], 0 offen sc1
    s_waitcnt vmcnt(0)
    v_subrev_u32 v80, s74, v80
    v_cmp_le_u32 vcc, 8, v80
    s_sub_u32 s60, s60, 1
    s_cbranch_scc1 L_x2_p_x
    s_cbranch_vccnz L_x2_p
L_x2_p_x:
L_x2_skip:
    s_barrier
    s_add_u32 s58, s58, 4194304
    s_mov_b32 s85, 1
    s_barrier
    ds_read_b128 v[64:67], v3 offset:0
    ds_read_b128 v[128:131], v11 offset:0
    ds_read_b128 v[68:71], v3 offset:2048
    ds_read_b128 v[132:135], v11 offset:2048
    ds_read_b128 v[72:75], v3 offset:4096
    ds_read_b128 v[136:139], v11 offset:4096
    ds_read_b128 v[76:79], v3 offset:6144
    ds_read_b128 v[140:143], v11 offset:6144
    s_waitcnt lgkmcnt(6)
    v_mfma_f32_32x32x16_bf16 v[32:47], v[64:67], v[128:131], 0
    s_barrier
    ds_read_b128 v[64:67], v3 offset:8192
    ds_read_b128 v[144:147], v11 offset:8192
    s_waitcnt lgkmcnt(6)
    v_mfma_f32_32x32x16_bf16 v[32:47], v[68:71], v[132:135], v[32:47]
    ds_read_b128 v[68:71], v3 offset:10240
    ds_read_b128 v[148:151], v11 offset:10240
    s_waitcnt lgkmcnt(6)
    v_mfma_f32_32x32x16_bf16 v[32:47], v[72:75], v[136:139], v[32:47]
    ds_read_b128 v[72:75], v3 offset:12288
    ds_read_b128 v[152:155], v11 offset:12288
    s_waitcnt lgkmcnt(6)
    v_mfma_f32_32x32x16_bf16 v[32:47], v[76:79], v[140:143], v[32:47]
    ds_read_b128 v[76:79], v3 offset:14336
    ds_read_b128 v[156:159], v11 offset:14336
    s_waitcnt lgkmcnt(6)
    v_mfma_f32_32x32x16_bf16 v[32:47], v[64:67], v[144:147], v[32:47]
    s_barrier
    ds_read_b128 v[64:67], v3 offset:16384
    ds_read_b128 v[160:163], v11 offset:16384
    s_waitcnt lgkmcnt(6)
    v_mfma_f32_32x32x16_bf16 v[32:47], v[68:71], v[148:151], v[32:47]
    ds_read_b128 v[68:71], v3 offset:18432
    ds_read_b128 v[164:167], v11 offset:18432
    s_waitcnt lgkmcnt(6)
    v_mfma_f32_32x32x16_bf16 v[32:47], v[72:75], v[152:155], v[32:47]
    ds_read_b128 v[72:75], v3 offset:20480
    ds_read_b128 v[168:171], v11 offset:20480
    s_waitcnt lgkmcnt(6)
    v_mfma_f32_32x32x16_bf16 v[32:47], v[76:79], v[156:159], v[32:47]
    ds_read_b128 v[76:79], v3 offset:22528
    ds_read_b128 v[172:175], v11 offset:22528
    s_waitcnt lgkmcnt(6)
    v_mfma_f32_32x32x16_bf16 v[32:47], v[64:67], v[160:163], v[32:47]
    s_barrier
    ds_read_b128 v[64:67], v3 offset:24576
    ds_read_b128 v[176:179], v11 offset:24576
    s_waitcnt lgkmcnt(6)
    v_mfma_f32_32x32x16_bf16 v[32:47], v[68:71], v[164:167], v[32:47]
    ds_read_b128 v[68:71], v3 offset:26624
    ds_read_b128 v[180:183], v11 offset:26624
    s_waitcnt lgkmcnt(6)
    v_mfma_f32_32x32x16_bf16 v[32:47], v[72:75], v[168:171], v[32:47]
    ds_read_b128 v[72:75], v3 offset:28672
    ds_read_b128 v[184:187], v11 offset:28672
    s_waitcnt lgkmcnt(6)
    v_mfma_f32_32x32x16_bf16 v[32:47], v[76:79], v[172:175], v[32:47]
    ds_read_b128 v[76:79], v3 offset:30720
    ds_read_b128 v[188:191], v11 offset:30720
    s_waitcnt lgkmcnt(6)
    v_mfma_f32_32x32x16_bf16 v[32:47], v[64:67], v[176:179], v[32:47]
    s_barrier
    ds_read_b128 v[64:67], v3 offset:32768
    ds_read_b128 v[192:195], v11 offset:32768
    s_waitcnt lgkmcnt(6)
    v_mfma_f32_32x32x16_bf16 v[32:47], v[68:71], v[180:183], v[32:47]
    ds_read_b128 v[68:71], v3 offset:34816
    ds_read_b128 v[196:199], v11 offset:34816
    s_waitcnt lgkmcnt(6)
    v_mfma_f32_32x32x16_bf16 v[32:47], v[72:75], v[184:187], v[32:47]
    ds_read_b128 v[72:75], v3 offset:36864
    ds_read_b128 v[200:203], v11 offset:36864
    s_waitcnt lgkmcnt(6)
    v_mfma_f32_32x32x16_bf16 v[32:47], v[76:79], v[188:191], v[32:47]
    ds_read_b128 v[76:79], v3 offset:38912
    ds_read_b128 v[204:207], v11 offset:38912
    s_waitcnt lgkmcnt(6)
    v_mfma_f32_32x32x16_bf16 v[32:47], v[64:67], v[192:195], v[32:47]
    s_barrier
    ds_read_b128 v[64:67], v3 offset:40960
    ds_read_b128 v[208:211], v11 offset:40960
    s_waitcnt lgkmcnt(6)
    v_mfma_f32_32x32x16_bf16 v[32:47], v[68:71], v[196:199], v[32:47]
    ds_read_b128 v[68:71], v3 offset:43008
    ds_read_b128 v[212:215], v11 offset:43008
    s_waitcnt lgkmcnt(6)
    v_mfma_f32_32x32x16_bf16 v[32:47], v[72:75], v[200:203], v[32:47]
    ds_read_b128 v[72:75], v3 offset:45056
    ds_read_b128 v[216:219], v11 offset:45056
    s_waitcnt lgkmcnt(6)
    v_mfma_f32_32x32x16_bf16 v[32:47], v[76:79], v[204:207], v[32:47]
    ds_read_b128 v[76:79], v3 offset:47104
    ds_read_b128 v[220:223], v11 offset:47104
    s_waitcnt lgkmcnt(6)
    v_mfma_f32_32x32x16_bf16 v[32:47], v[64:67], v[208:211], v[32:47]
    s_barrier
    ds_read_b128 v[64:67], v3 offset:49152
    ds_read_b128 v[224:227], v11 offset:49152
    s_waitcnt lgkmcnt(6)
    v_mfma_f32_32x32x16_bf16 v[32:47], v[68:71], v[212:215], v[32:47]
    ds_read_b128 v[68:71], v3 offset:51200
    ds_read_b128 v[228:231], v11 offset:51200
    s_waitcnt lgkmcnt(6)
    v_mfma_f32_32x32x16_bf16 v[32:47], v[72:75], v[216:219], v[32:47]
    ds_read_b128 v[72:75], v3 offset:53248
    ds_read_b128 v[232:235], v11 offset:53248
    s_waitcnt lgkmcnt(6)
    v_mfma_f32_32x32x16_bf16 v[32:47], v[76:79], v[220:223], v[32:47]
    ds_read_b128 v[76:79], v3 offset:55296
    ds_read_b128 v[236:239], v11 offset:55296
    s_waitcnt lgkmcnt(6)
    v_mfma_f32_32x32x16_bf16 v[32:47], v[64:67], v[224:227], v[32:47]
    s_barrier
    ds_read_b128 v[64:67], v3 offset:57344
    ds_read_b128 v[240:243], v11 offset:57344
    s_waitcnt lgkmcnt(6)
    v_mfma_f32_32x32x16_bf16 v[32:47], v[68:71], v[228:231], v[32:47]
    ds_read_b128 v[68:71], v3 offset:59392
    ds_read_b128 v[244:247], v11 offset:59392
    s_waitcnt lgkmcnt(6)
    v_mfma_f32_32x32x16_bf16 v[32:47], v[72:75], v[232:235], v[32:47]
    ds_read_b128 v[72:75], v3 offset:61440
    ds_read_b128 v[248:251], v11 offset:61440
    s_waitcnt lgkmcnt(6)
    v_mfma_f32_32x32x16_bf16 v[32:47], v[76:79], v[236:239], v[32:47]
    ds_read_b128 v[76:79], v3 offset:63488
    ds_read_b128 v[252:255], v11 offset:63488
    s_waitcnt lgkmcnt(6)
    v_mfma_f32_32x32x16_bf16 v[32:47], v[64:67], v[240:243], v[32:47]
    s_barrier
    ds_read_b128 v[64:67], v4 offset:0
    s_waitcnt lgkmcnt(5)
    v_mfma_f32_32x32x16_bf16 v[32:47], v[68:71], v[244:247], v[32:47]
    ds_read_b128 v[68:71], v4 offset:2048
    s_waitcnt lgkmcnt(4)
    v_mfma_f32_32x32x16_bf16 v[32:47], v[72:75], v[248:251], v[32:47]
    ds_read_b128 v[72:75], v4 offset:4096
    s_waitcnt lgkmcnt(3)
    v_mfma_f32_32x32x16_bf16 v[32:47], v[76:79], v[252:255], v[32:47]
    ds_read_b128 v[76:79], v4 offset:6144
    s_waitcnt lgkmcnt(3)
    v_mfma_f32_32x32x16_bf16 v[48:63], v[128:131], v[64:67], 0
    s_barrier
    ds_read_b128 v[64:67], v4 offset:8192
    s_waitcnt lgkmcnt(3)
    v_mfma_f32_32x32x16_bf16 v[48:63], v[132:135], v[68:71], v[48:63]
    ds_read_b128 v[68:71], v4 offset:10240
    s_waitcnt lgkmcnt(3)
    v_mfma_f32_32x32x16_bf16 v[48:63], v[136:139], v[72:75], v[48:63]
    ds_read_b128 v[72:75], v4 offset:12288
    s_waitcnt lgkmcnt(3)
    v_mfma_f32_32x32x16_bf16 v[48:63], v[140:143], v[76:79], v[48:63]
    ds_read_b128 v[76:79], v4 offset:14336
    v_add_u32 v82, 155648, v13
    v_add_u32 v83, 155648, v12
    ds_read_b32 v80, v82 offset:0
    ds_read_b32 v81, v82 offset:256
    s_waitcnt lgkmcnt(5)
    v_mfma_f32_32x32x16_bf16 v[48:63], v[144:147], v[64:67], v[48:63]
    s_barrier
    ds_read_b128 v[64:67], v4 offset:16384
    ds_read_b128 v[96:99], v83 offset:5632
    ds_read_b128 v[100:103], v83 offset:5664
    ds_read_b128 v[104:107], v83 offset:5696
    ds_read_b128 v[108:111], v83 offset:5728
    s_waitcnt lgkmcnt(9)
    v_mfma_f32_32x32x16_bf16 v[48:63], v[148:151], v[68:71], v[48:63]
    ds_read_b128 v[68:71], v4 offset:18432
    s_waitcnt lgkmcnt(9)
    v_mfma_f32_32x32x16_bf16 v[48:63], v[152:155], v[72:75], v[48:63]
    ds_read_b128 v[72:75], v4 offset:20480
    s_waitcnt lgkmcnt(5)
    v_fma_f32 v92, -v80, v96, v32
    v_fma_f32 v93, -v80, v97, v33
    v_mfma_f32_32x32x16_bf16 v[48:63], v[156:159], v[76:79], v[48:63]
    ds_read_b128 v[76:79], v4 offset:22528
    v_fma_f32 v94, -v80, v98, v34
    v_fma_f32 v95, -v80, v99, v35
    v_mul_f32 v92, v92, v81
    v_mul_f32 v93, v93, v81
    v_mfma_f32_32x32x16_bf16 v[48:63], v[160:163], v[64:67], v[48:63]
    s_barrier
    ds_read_b128 v[64:67], v3 offset:0
    v_mul_f32 v94, v94, v81
    v_mul_f32 v95, v95, v81
    v_cvt_pk_bf16_f32 v84, v92, v93
    v_cvt_pk_bf16_f32 v85, v94, v95
    s_waitcnt lgkmcnt(3)
    v_mfma_f32_32x32x16_bf16 v[48:63], v[164:167], v[68:71], v[48:63]
    ds_read_b128 v[68:71], v3 offset:2048
    v_fma_f32 v92, -v80, v100, v36
    v_fma_f32 v93, -v80, v101, v37
    v_fma_f32 v94, -v80, v102, v38
    v_fma_f32 v95, -v80, v103, v39
    s_waitcnt lgkmcnt(3)
    v_mfma_f32_32x32x16_bf16 v[48:63], v[168:171], v[72:75], v[48:63]
    ds_read_b128 v[72:75], v3 offset:4096
    v_mul_f32 v92, v92, v81
    v_mul_f32 v93, v93, v81
    v_mul_f32 v94, v94, v81
    v_mul_f32 v95, v95, v81
    s_waitcnt lgkmcnt(3)
    v_mfma_f32_32x32x16_bf16 v[48:63], v[172:175], v[76:79], v[48:63]
    ds_read_b128 v[76:79], v3 offset:6144
    v_cvt_pk_bf16_f32 v86, v92, v93
    v_cvt_pk_bf16_f32 v87, v94, v95
    v_fma_f32 v92, -v80, v104, v40
    v_fma_f32 v93, -v80, v105, v41
    s_waitcnt lgkmcnt(3)
    v_mfma_f32_32x32x16_bf16 v[48:63], v[176:179], v[64:67], v[48:63]
    s_barrier
    ds_read_b128 v[64:67], v3 offset:8192
    v_fma_f32 v94, -v80, v106, v42
    v_fma_f32 v95, -v80, v107, v43
    v_mul_f32 v92, v92, v81
    v_mul_f32 v93, v93, v81
    s_waitcnt lgkmcnt(3)
    v_mfma_f32_32x32x16_bf16 v[48:63], v[180:183], v[68:71], v[48:63]
    ds_read_b128 v[68:71], v3 offset:10240
    v_mul_f32 v94, v94, v81
    v_mul_f32 v95, v95, v81
    v_cvt_pk_bf16_f32 v88, v92, v93
    v_cvt_pk_bf16_f32 v89, v94, v95
    s_waitcnt lgkmcnt(3)
    v_mfma_f32_32x32x16_bf16 v[48:63], v[184:187], v[72:75], v[48:63]
    ds_read_b128 v[72:75], v3 offset:12288
    v_fma_f32 v92, -v80, v108, v44
    v_fma_f32 v93, -v80, v109, v45
    v_fma_f32 v94, -v80, v110, v46
    v_fma_f32 v95, -v80, v111, v47
    s_waitcnt lgkmcnt(3)
    v_mfma_f32_32x32x16_bf16 v[48:63], v[188:191], v[76:79], v[48:63]
    ds_read_b128 v[76:79], v3 offset:14336
    v_mul_f32 v92, v92, v81
    v_mul_f32 v93, v93, v81
    v_mul_f32 v94, v94, v81
    v_mul_f32 v95, v95, v81
    s_waitcnt lgkmcnt(3)
    v_mfma_f32_32x32x16_bf16 v[48:63], v[192:195], v[64:67], v[48:63]
    s_barrier
    ds_read_b128 v[64:67], v3 offset:16384
    v_cvt_pk_bf16_f32 v90, v92, v93
    v_cvt_pk_bf16_f32 v91, v94, v95
    s_lshl_b32 s50, s42, 12
    s_lshl_b32 s51, s43, 11
    s_waitcnt lgkmcnt(3)
    v_mfma_f32_32x32x16_bf16 v[48:63], v[196:199], v[68:71], v[48:63]
    ds_read_b128 v[68:71], v3 offset:18432
    s_add_u32 s50, s50, s51
    v_add_u32 v82, s50, v1
    ds_write_b128 v82, v[84:87] offset:32768
    s_waitcnt lgkmcnt(4)
    v_mfma_f32_32x32x16_bf16 v[48:63], v[200:203], v[72:75], v[48:63]
    ds_read_b128 v[72:75], v3 offset:20480
    ds_write_b128 v82, v[88:91] offset:33792
    s_waitcnt lgkmcnt(5)
    v_mfma_f32_32x32x16_bf16 v[48:63], v[204:207], v[76:79], v[48:63]
    ds_read_b128 v[76:79], v3 offset:22528
    buffer_store_dwordx4 v[84:87], v1, s[24:27], s58 offen offset:0 sc1
    buffer_store_dwordx4 v[88:91], v1, s[24:27], s58 offen offset:1024 sc1
    s_waitcnt lgkmcnt(5)
    v_mfma_f32_32x32x16_bf16 v[48:63], v[208:211], v[64:67], v[48:63]
    s_barrier
    ds_read_b128 v[64:67], v3 offset:24576
    s_waitcnt lgkmcnt(5)
    v_mfma_f32_32x32x16_bf16 v[48:63], v[212:215], v[68:71], v[48:63]
    ds_read_b128 v[68:71], v3 offset:26624
    s_waitcnt lgkmcnt(4)
    v_mfma_f32_32x32x16_bf16 v[48:63], v[216:219], v[72:75], v[48:63]
    ds_read_b128 v[72:75], v3 offset:28672
    s_waitcnt lgkmcnt(3)
    v_mfma_f32_32x32x16_bf16 v[48:63], v[220:223], v[76:79], v[48:63]
    ds_read_b128 v[76:79], v3 offset:30720
    s_waitcnt lgkmcnt(3)
    v_mfma_f32_32x32x16_bf16 v[48:63], v[224:227], v[64:67], v[48:63]
    s_barrier
    ds_read_b128 v[64:67], v3 offset:32768
    s_waitcnt lgkmcnt(3)
    v_mfma_f32_32x32x16_bf16 v[48:63], v[228:231], v[68:71], v[48:63]
    ds_read_b128 v[68:71], v3 offset:34816
    s_waitcnt lgkmcnt(3)
    v_mfma_f32_32x32x16_bf16 v[48:63], v[232:235], v[72:75], v[48:63]
    ds_read_b128 v[72:75], v3 offset:36864
    s_waitcnt lgkmcnt(3)
    v_mfma_f32_32x32x16_bf16 v[48:63], v[236:239], v[76:79], v[48:63]
    ds_read_b128 v[76:79], v3 offset:38912
    s_waitcnt lgkmcnt(3)
    v_mfma_f32_32x32x16_bf16 v[48:63], v[240:243], v[64:67], v[48:63]
    s_barrier
    ds_read_b128 v[64:67], v2 offset:0
    s_waitcnt lgkmcnt(3)
    v_mfma_f32_32x32x16_bf16 v[48:63], v[244:247], v[68:71], v[48:63]
    ds_read_b128 v[68:71], v2 offset:2048
    s_waitcnt lgkmcnt(3)
    v_mfma_f32_32x32x16_bf16 v[48:63], v[248:251], v[72:75], v[48:63]
    ds_read_b128 v[72:75], v2 offset:4096
    s_waitcnt lgkmcnt(3)
    v_mfma_f32_32x32x16_bf16 v[48:63], v[252:255], v[76:79], v[48:63]
    ds_read_b128 v[76:79], v2 offset:6144
    s_waitcnt lgkmcnt(3)
    v_mfma_f32_32x32x16_bf16 v[32:47], v[64:67], v[128:131], 0
    s_barrier
    ds_read_b128 v[64:67], v2 offset:8192
    s_waitcnt lgkmcnt(3)
    v_mfma_f32_32x32x16_bf16 v[32:47], v[68:71], v[132:135], v[32:47]
    ds_read_b128 v[68:71], v2 offset:10240
    s_waitcnt lgkmcnt(3)
    v_mfma_f32_32x32x16_bf16 v[32:47], v[72:75], v[136:139], v[32:47]
    ds_read_b128 v[72:75], v2 offset:12288
    s_waitcnt lgkmcnt(3)
    v_mfma_f32_32x32x16_bf16 v[32:47], v[76:79], v[140:143], v[32:47]
    ds_read_b128 v[76:79], v2 offset:14336
    v_and_b32 v82, 31, v0
    v_lshlrev_b32 v82, 2, v82
    s_lshl_b32 s50, s43, 7
    s_add_u32 s50, s50, 155648
    s_waitcnt lgkmcnt(3)
    v_mfma_f32_32x32x16_bf16 v[32:47], v[64:67], v[144:147], v[32:47]
    s_barrier
    ds_read_b128 v[64:67], v2 offset:16384
    v_add_u32 v82, s50, v82
    v_add_u32 v83, 155648, v14
    ds_read_b32 v80, v82 offset:5888
    ds_read_b128 v[96:99], v83 offset:0
    s_waitcnt lgkmcnt(5)
    v_mfma_f32_32x32x16_bf16 v[32:47], v[68:71], v[148:151], v[32:47]
    ds_read_b128 v[68:71], v2 offset:18432
    ds_read_b128 v[100:103], v83 offset:256
    s_waitcnt lgkmcnt(6)
    v_mfma_f32_32x32x16_bf16 v[32:47], v[72:75], v[152:155], v[32:47]
    ds_read_b128 v[72:75], v2 offset:20480
    ds_read_b128 v[104:107], v83 offset:32
    s_waitcnt lgkmcnt(7)
    v_mfma_f32_32x32x16_bf16 v[32:47], v[76:79], v[156:159], v[32:47]
    ds_read_b128 v[76:79], v2 offset:22528
    ds_read_b128 v[108:111], v83 offset:288
    s_waitcnt lgkmcnt(6)
    v_fma_f32 v92, -v96, v80, v48
    v_fma_f32 v93, -v97, v80, v49
    v_fma_f32 v94, -v98, v80, v50
    v_mfma_f32_32x32x16_bf16 v[32:47], v[64:67], v[160:163], v[32:47]
    s_barrier
    ds_read_b128 v[64:67], v2 offset:24576
    v_fma_f32 v95, -v99, v80, v51
    s_waitcnt lgkmcnt(5)
    v_mul_f32 v92, v92, v100
    v_mul_f32 v93, v93, v101
    v_mul_f32 v94, v94, v102
    v_mfma_f32_32x32x16_bf16 v[32:47], v[68:71], v[164:167], v[32:47]
    ds_read_b128 v[68:71], v2 offset:26624
    v_mul_f32 v95, v95, v103
    v_cvt_pk_bf16_f32 v84, v92, v93
    v_cvt_pk_bf16_f32 v85, v94, v95
    ds_read_b128 v[96:99], v83 offset:64
    s_waitcnt lgkmcnt(6)
    v_mfma_f32_32x32x16_bf16 v[32:47], v[72:75], v[168:171], v[32:47]
    ds_read_b128 v[72:75], v2 offset:28672
    ds_read_b128 v[100:103], v83 offset:320
    s_waitcnt lgkmcnt(7)
    v_fma_f32 v92, -v104, v80, v52
    v_fma_f32 v93, -v105, v80, v53
    v_fma_f32 v94, -v106, v80, v54
    s_waitcnt lgkmcnt(6)
    v_mfma_f32_32x32x16_bf16 v[32:47], v[76:79], v[172:175], v[32:47]
    ds_read_b128 v[76:79], v2 offset:30720
    v_fma_f32 v95, -v107, v80, v55
    s_waitcnt lgkmcnt(6)
    v_mul_f32 v92, v92, v108
    v_mul_f32 v93, v93, v109
    v_mul_f32 v94, v94, v110
    s_waitcnt lgkmcnt(5)
    v_mfma_f32_32x32x16_bf16 v[32:47], v[64:67], v[176:179], v[32:47]
    s_barrier
    ds_read_b128 v[64:67], v2 offset:40960
    v_mul_f32 v95, v95, v111
    v_cvt_pk_bf16_f32 v86, v92, v93
    v_cvt_pk_bf16_f32 v87, v94, v95
    ds_read_b128 v[104:107], v83 offset:96
    s_waitcnt lgkmcnt(6)
    v_mfma_f32_32x32x16_bf16 v[32:47], v[68:71], v[180:183], v[32:47]
    ds_read_b128 v[68:71], v2 offset:43008
    ds_read_b128 v[108:111], v83 offset:352
    s_waitcnt lgkmcnt(7)
    v_fma_f32 v92, -v96, v80, v56
    v_fma_f32 v93, -v97, v80, v57
    v_fma_f32 v94, -v98, v80, v58
    s_waitcnt lgkmcnt(6)
    v_mfma_f32_32x32x16_bf16 v[32:47], v[72:75], v[184:187], v[32:47]
    ds_read_b128 v[72:75], v2 offset:45056
    v_fma_f32 v95, -v99, v80, v59
    s_waitcnt lgkmcnt(6)
    v_mul_f32 v92, v92, v100
    v_mul_f32 v93, v93, v101
    v_mul_f32 v94, v94, v102
    s_waitcnt lgkmcnt(5)
    v_mfma_f32_32x32x16_bf16 v[32:47], v[76:79], v[188:191], v[32:47]
    ds_read_b128 v[76:79], v2 offset:47104
    v_mul_f32 v95, v95, v103
    v_cvt_pk_bf16_f32 v88, v92, v93
    v_cvt_pk_bf16_f32 v89, v94, v95
    s_waitcnt lgkmcnt(4)
    v_fma_f32 v92, -v104, v80, v60
    v_mfma_f32_32x32x16_bf16 v[32:47], v[64:67], v[192:195], v[32:47]
    s_barrier
    ds_read_b128 v[64:67], v2 offset:49152
    v_fma_f32 v93, -v105, v80, v61
    v_fma_f32 v94, -v106, v80, v62
    v_fma_f32 v95, -v107, v80, v63
    s_waitcnt lgkmcnt(3)
    v_mul_f32 v92, v92, v108
    v_mfma_f32_32x32x16_bf16 v[32:47], v[68:71], v[196:199], v[32:47]
    ds_read_b128 v[68:71], v2 offset:51200
    v_mul_f32 v93, v93, v109
    v_mul_f32 v94, v94, v110
    v_mul_f32 v95, v95, v111
    v_cvt_pk_bf16_f32 v90, v92, v93
    s_waitcnt lgkmcnt(3)
    v_mfma_f32_32x32x16_bf16 v[32:47], v[72:75], v[200:203], v[32:47]
    ds_read_b128 v[72:75], v2 offset:53248
    v_cvt_pk_bf16_f32 v91, v94, v95
    v_bfe_u32 v82, v0, 4, 1
    v_lshlrev_b32 v82, 10, v82
    v_lshrrev_b32 v81, 5, v0
    s_waitcnt lgkmcnt(3)
    v_mfma_f32_32x32x16_bf16 v[32:47], v[76:79], v[204:207], v[32:47]
    ds_read_b128 v[76:79], v2 offset:55296
    v_lshl_add_u32 v82, v81, 8, v82
    v_and_b32 v81, 15, v0
    v_lshl_add_u32 v82, v81, 4, v82
    s_lshl_b32 s50, s42, 12
    s_waitcnt lgkmcnt(3)
    v_mfma_f32_32x32x16_bf16 v[32:47], v[64:67], v[208:211], v[32:47]
    s_waitcnt vmcnt(0)
    s_barrier
    ds_read_b128 v[64:67], v2 offset:57344
    s_lshl_b32 s51, s43, 11
    s_add_u32 s50, s50, s51
    s_add_u32 s50, s50, 73728
    v_add_u32 v83, s50, v82
    s_waitcnt lgkmcnt(3)
    v_mfma_f32_32x32x16_bf16 v[32:47], v[68:71], v[212:215], v[32:47]
    ds_read_b128 v[68:71], v2 offset:59392
    s_add_u32 s51, s58, 8192
    ds_write_b128 v83, v[84:87] offset:0
    s_waitcnt lgkmcnt(4)
    v_mfma_f32_32x32x16_bf16 v[32:47], v[72:75], v[216:219], v[32:47]
    ds_read_b128 v[72:75], v2 offset:61440
    ds_write_b128 v83, v[88:91] offset:512
    s_waitcnt lgkmcnt(5)
    v_mfma_f32_32x32x16_bf16 v[32:47], v[76:79], v[220:223], v[32:47]
    ds_read_b128 v[76:79], v2 offset:63488
    buffer_store_dwordx4 v[84:87], v82, s[24:27], s51 offen offset:0 sc1
    buffer_store_dwordx4 v[88:91], v82, s[24:27], s51 offen offset:512 sc1
    s_waitcnt lgkmcnt(5)
    v_mfma_f32_32x32x16_bf16 v[32:47], v[64:67], v[224:227], v[32:47]
    s_barrier
    ds_read_b128 v[64:67], v3 offset:0
    s_waitcnt lgkmcnt(5)
    v_mfma_f32_32x32x16_bf16 v[32:47], v[68:71], v[228:231], v[32:47]
    ds_read_b128 v[68:71], v3 offset:2048
    s_waitcnt lgkmcnt(4)
    v_mfma_f32_32x32x16_bf16 v[32:47], v[72:75], v[232:235], v[32:47]
    ds_read_b128 v[72:75], v3 offset:4096
    s_waitcnt lgkmcnt(3)
    v_mfma_f32_32x32x16_bf16 v[32:47], v[76:79], v[236:239], v[32:47]
    ds_read_b128 v[76:79], v3 offset:6144
    s_waitcnt lgkmcnt(3)
    v_mfma_f32_32x32x16_bf16 v[32:47], v[64:67], v[240:243], v[32:47]
    s_waitcnt lgkmcnt(2)
    v_mfma_f32_32x32x16_bf16 v[32:47], v[68:71], v[244:247], v[32:47]
    s_waitcnt lgkmcnt(1)
    v_mfma_f32_32x32x16_bf16 v[32:47], v[72:75], v[248:251], v[32:47]
    s_waitcnt lgkmcnt(0)
    v_mfma_f32_32x32x16_bf16 v[32:47], v[76:79], v[252:255], v[32:47]
    s_nop 11
    s_barrier
    v_add_u32 v82, 155648, v13
    v_add_u32 v83, 155648, v12
    ds_read_b32 v80, v82 offset:0
    ds_read_b32 v81, v82 offset:256
    ds_read_b128 v[96:99], v83 offset:6144
    ds_read_b128 v[100:103], v83 offset:6176
    ds_read_b128 v[104:107], v83 offset:6208
    ds_read_b128 v[108:111], v83 offset:6240
    s_waitcnt lgkmcnt(4)
    v_mul_f32 v81, s84, v81
    s_waitcnt lgkmcnt(3)
    v_fma_f32 v92, -v80, v96, v32
    v_fma_f32 v93, -v80, v97, v33
    v_fma_f32 v94, -v80, v98, v34
    v_fma_f32 v95, -v80, v99, v35
    v_mul_f32 v92, v92, v81
    v_mul_f32 v93, v93, v81
    v_mul_f32 v94, v94, v81
    v_mul_f32 v95, v95, v81
    v_cvt_pk_bf16_f32 v84, v92, v93
    v_cvt_pk_bf16_f32 v85, v94, v95
    s_waitcnt lgkmcnt(2)
    v_fma_f32 v92, -v80, v100, v36
    v_fma_f32 v93, -v80, v101, v37
    v_fma_f32 v94, -v80, v102, v38
    v_fma_f32 v95, -v80, v103, v39
    v_mul_f32 v92, v92, v81
    v_mul_f32 v93, v93, v81
    v_mul_f32 v94, v94, v81
    v_mul_f32 v95, v95, v81
    v_cvt_pk_bf16_f32 v86, v92, v93
    v_cvt_pk_bf16_f32 v87, v94, v95
    s_waitcnt lgkmcnt(1)
    v_fma_f32 v92, -v80, v104, v40
    v_fma_f32 v93, -v80, v105, v41
    v_fma_f32 v94, -v80, v106, v42
    v_fma_f32 v95, -v80, v107, v43
    v_mul_f32 v92, v92, v81
    v_mul_f32 v93, v93, v81
    v_mul_f32 v94, v94, v81
    v_mul_f32 v95, v95, v81
    v_cvt_pk_bf16_f32 v88, v92, v93
    v_cvt_pk_bf16_f32 v89, v94, v95
    s_waitcnt lgkmcnt(0)
    v_fma_f32 v92, -v80, v108, v44
    v_fma_f32 v93, -v80, v109, v45
    v_fma_f32 v94, -v80, v110, v46
    v_fma_f32 v95, -v80, v111, v47
    v_mul_f32 v92, v92, v81
    v_mul_f32 v93, v93, v81
    v_mul_f32 v94, v94, v81
    v_mul_f32 v95, v95, v81
    v_cvt_pk_bf16_f32 v90, v92, v93
    v_cvt_pk_bf16_f32 v91, v94, v95
    s_lshl_b32 s50, s42, 10
    s_lshl_b32 s51, s43, 12
    s_add_u32 s50, s50, s51
    s_add_u32 s50, s50, 81920
    v_add_u32 v82, s50, v1
    ds_write_b128 v82, v[84:87] offset:0
    ds_write_b128 v82, v[88:91] offset:2048
    s_waitcnt vmcnt(0) lgkmcnt(0)
    v_mov_b32 v80, 162820
    v_mov_b32 v81, 1
    s_mov_b64 exec, 1
    ds_add_u32 v80, v81
    s_mov_b64 exec, -1
    s_cmp_lg_u32 s38, 0
    s_cbranch_scc1 L_p1b_vm_x
    s_mov_b32 s60, 400000
L_p1b_vm:
    ds_read_b32 v81, v80
    s_waitcnt lgkmcnt(0)
    v_cmp_gt_u32 vcc, 12, v81
    s_sub_u32 s60, s60, 1
    s_cbranch_scc1 L_p1b_vm_y
    s_cbranch_vccnz L_p1b_vm
L_p1b_vm_y:
    s_cmp_lg_u32 s38, 0
    s_cbranch_scc1 L_p1b_vf_skip
    s_lshl_b32 s50, s36, 3
    s_add_u32 s50, s50, s37
    s_lshl_b32 s50, s50, 7
    s_add_u32 s50, s50, 8196
    s_add_u32 s74, s85, 1
    s_add_u32 s74, s74, s87
    v_mov_b32 v81, s74
    v_mov_b32 v82, s50
    s_mov_b64 s[70:71], exec
    s_mov_b64 exec, 1
    buffer_store_dword v81, v82, s[24:27], 0 offen sc1
    s_mov_b64 exec, s[70:71]
L_p1b_vf_skip:
L_p1b_vm_x:
    s_waitcnt lgkmcnt(0)
    s_barrier
    s_mov_b32 s40, 1
    s_branch L_c_loop
L_c_final:
    s_lshl_b32 s50, s38, 12
    s_add_u32 s50, s50, 0
    v_add_u32 v96, s50, v1
    s_xor_b32 s51, s38, 1
    s_lshl_b32 s51, s51, 12
    s_add_u32 s51, s51, 0
    v_add_u32 v97, s51, v1
    v_add_u32 v98, 155648, v12
    ds_read_b128 v[100:103], v98 offset:4352
    ds_read_b128 v[104:107], v98 offset:4384
    ds_read_b128 v[108:111], v98 offset:4416
    ds_read_b128 v[112:115], v98 offset:4448
    s_nop 7
    ds_write_b128 v96, v[48:51] offset:0
    ds_write_b128 v96, v[52:55] offset:1024
    ds_write_b128 v96, v[56:59] offset:2048
    ds_write_b128 v96, v[60:63] offset:3072
    s_waitcnt lgkmcnt(0)
    s_barrier
    ds_read_b128 v[80:83], v97 offset:0
    ds_read_b128 v[84:87], v97 offset:1024
    ds_read_b128 v[88:91], v97 offset:2048
    ds_read_b128 v[92:95], v97 offset:3072
    v_pk_add_f32 v[16:17], v[16:17], v[32:33]
    v_pk_add_f32 v[18:19], v[18:19], v[34:35]
    v_pk_add_f32 v[20:21], v[20:21], v[36:37]
    v_pk_add_f32 v[22:23], v[22:23], v[38:39]
    v_pk_add_f32 v[24:25], v[24:25], v[40:41]
    v_pk_add_f32 v[26:27], v[26:27], v[42:43]
    v_pk_add_f32 v[28:29], v[28:29], v[44:45]
    v_pk_add_f32 v[30:31], v[30:31], v[46:47]
    v_pk_add_f32 v[16:17], v[16:17], v[100:101]
    v_pk_add_f32 v[18:19], v[18:19], v[102:103]
    v_pk_add_f32 v[20:21], v[20:21], v[104:105]
    v_pk_add_f32 v[22:23], v[22:23], v[106:107]
    v_pk_add_f32 v[24:25], v[24:25], v[108:109]
    v_pk_add_f32 v[26:27], v[26:27], v[110:111]
    v_pk_add_f32 v[28:29], v[28:29], v[112:113]
    v_pk_add_f32 v[30:31], v[30:31], v[114:115]
    s_waitcnt lgkmcnt(0)
    v_pk_add_f32 v[16:17], v[16:17], v[80:81]
    v_pk_add_f32 v[18:19], v[18:19], v[82:83]
    v_pk_add_f32 v[20:21], v[20:21], v[84:85]
    v_pk_add_f32 v[22:23], v[22:23], v[86:87]
    v_pk_add_f32 v[24:25], v[24:25], v[88:89]
    v_pk_add_f32 v[26:27], v[26:27], v[90:91]
    v_pk_add_f32 v[28:29], v[28:29], v[92:93]
    v_pk_add_f32 v[30:31], v[30:31], v[94:95]
    v_cvt_pk_bf16_f32 v116, v16, v17
    v_cvt_pk_bf16_f32 v117, v18, v19
    v_cvt_pk_bf16_f32 v118, v20, v21
    v_cvt_pk_bf16_f32 v119, v22, v23
    v_cvt_pk_bf16_f32 v120, v24, v25
    v_cvt_pk_bf16_f32 v121, v26, v27
    v_cvt_pk_bf16_f32 v122, v28, v29
    v_cvt_pk_bf16_f32 v123, v30, v31
    s_nop 1
    v_permlane32_swap_b32 v116, v118
    v_permlane32_swap_b32 v117, v119
    v_permlane32_swap_b32 v120, v122
    v_permlane32_swap_b32 v121, v123
    v_and_b32 v96, 15, v0
    v_lshlrev_b32 v96, 10, v96
    v_bfe_u32 v97, v0, 4, 1
    v_lshl_add_u32 v96, v97, 5, v96
    v_lshrrev_b32 v97, 5, v0
    v_lshl_add_u32 v96, v97, 4, v96
    v_permlane16_swap_b32 v116, v120
    v_permlane16_swap_b32 v117, v121
    v_permlane16_swap_b32 v118, v122
    v_permlane16_swap_b32 v119, v123
    s_add_u32 s50, s75, 16384
    buffer_store_dwordx4 v[116:119], v96, s[28:31], s75 offen nt
    buffer_store_dwordx4 v[120:123], v96, s[28:31], s50 offen nt
    s_or_b32 s50, s36, s37
    s_or_b32 s50, s50, s38
    s_cmp_lg_u32 s50, 0
    s_cbranch_scc1 L_c_noep
    v_mov_b32 v80, s87
    v_mov_b32 v81, 32505856
    s_mov_b64 s[70:71], exec
    s_mov_b64 exec, 1
    buffer_store_dword v80, v81, s[24:27], 0 offen sc1
    s_mov_b64 exec, s[70:71]
L_c_noep:
    s_waitcnt vmcnt(0)
    s_endpgm
L_loader:
    s_setprio 1
    s_cmp_eq_u32 s38, 7
    s_cbranch_scc1 L_prep7
    v_lshrrev_b32 v16, 3, v0
    v_bfe_u32 v17, v0, 4, 2
    v_and_b32 v18, 1, v17
    v_lshlrev_b32 v18, 1, v18
    v_lshrrev_b32 v17, 1, v17
    v_or_b32 v17, v17, v18
    v_bfe_u32 v18, v0, 1, 2
    v_xor_b32 v17, v17, v18
    v_lshlrev_b32 v17, 5, v17
    v_and_b32 v18, 1, v0
    v_lshl_add_u32 v17, v18, 4, v17
    s_mov_b32 s49, 3072
    v_mul_lo_u32 v18, v16, s49
    v_add_u32 v2, v18, v17
    s_sub_u32 s50, s38, 4
    s_add_u32 s51, s50, 1
    s_cmp_eq_u32 s50, 2
    s_cselect_b32 s51, 0, s51
    s_mul_i32 s88, s36, 49152
    s_lshl_b32 s51, s51, 10
    s_add_u32 s88, s88, s51
    s_lshl_b32 s51, s37, 7
    s_add_u32 s88, s88, s51
    s_lshl_b32 s52, s38, 12
    s_add_u32 m0, s52, 122880
    s_add_u32 s49, s88, 0
    buffer_load_dwordx4 v2, s[8:11], s49 offen lds
    s_lshl_b32 s52, s38, 12
    s_add_u32 m0, s52, 123904
    s_add_u32 s49, s88, 24576
    buffer_load_dwordx4 v2, s[8:11], s49 offen lds
    s_mul_i32 s89, s37, 196608
    s_lshl_b32 s51, s36, 11
    s_add_u32 s89, s89, s51
    s_lshl_b32 s51, s50, 16
    s_add_u32 s89, s89, s51
    s_add_u32 s89, s89, 20971520
    s_branch L_prep_go
L_prep7:
    v_lshrrev_b32 v16, 3, v0
    v_bfe_u32 v17, v0, 4, 2
    v_and_b32 v18, 1, v17
    v_lshlrev_b32 v18, 1, v18
    v_lshrrev_b32 v17, 1, v17
    v_or_b32 v17, v17, v18
    v_bfe_u32 v18, v0, 1, 2
    v_xor_b32 v17, v17, v18
    v_lshlrev_b32 v17, 5, v17
    v_and_b32 v18, 1, v0
    v_lshl_add_u32 v17, v18, 4, v17
    s_mov_b32 s49, 1024
    v_mul_lo_u32 v18, v16, s49
    v_add_u32 v4, v18, v17
    s_lshl_b32 s88, s36, 14
    s_lshl_b32 s51, s37, 7
    s_add_u32 s88, s88, s51
    s_lshl_b32 s52, s38, 12
    s_add_u32 m0, s52, 122880
    s_add_u32 s49, s88, 0
    buffer_load_dwordx4 v4, s[12:15], s49 offen lds
    s_lshl_b32 s52, s38, 12
    s_add_u32 m0, s52, 123904
    s_add_u32 s49, s88, 8192
    buffer_load_dwordx4 v4, s[12:15], s49 offen lds
    s_lshl_b32 s89, s36, 11
    s_lshl_b32 s51, s37, 16
    s_add_u32 s89, s89, s51
    s_add_u32 s89, s89, 25165824
L_prep_go:
    s_mov_b32 s51, 0
    v_lshrrev_b32 v60, 5, v0
    v_lshlrev_b32 v60, 2, v60
    v_bfe_u32 v63, v0, 2, 2
    v_add_u32 v60, v60, v63
    v_lshrrev_b32 v61, 1, v60
    v_and_b32 v61, 3, v61
    v_and_b32 v62, 1, v61
    v_lshlrev_b32 v62, 1, v62
    v_lshrrev_b32 v61, 1, v61
    v_or_b32 v61, v61, v62
    v_lshrrev_b32 v62, 4, v0
    v_and_b32 v62, 1, v62
    s_lshl_b32 s52, s51, 1
    v_add_u32 v62, s52, v62
    v_xor_b32 v61, v61, v62
    v_lshlrev_b32 v61, 5, v61
    v_lshlrev_b32 v60, 7, v60
    v_and_b32 v62, 3, v0
    v_lshlrev_b32 v62, 3, v62
    v_add3_u32 v40, v60, v61, v62
    s_mov_b32 s51, 1
    v_lshrrev_b32 v60, 5, v0
    v_lshlrev_b32 v60, 2, v60
    v_bfe_u32 v63, v0, 2, 2
    v_add_u32 v60, v60, v63
    v_lshrrev_b32 v61, 1, v60
    v_and_b32 v61, 3, v61
    v_and_b32 v62, 1, v61
    v_lshlrev_b32 v62, 1, v62
    v_lshrrev_b32 v61, 1, v61
    v_or_b32 v61, v61, v62
    v_lshrrev_b32 v62, 4, v0
    v_and_b32 v62, 1, v62
    s_lshl_b32 s52, s51, 1
    v_add_u32 v62, s52, v62
    v_xor_b32 v61, v61, v62
    v_lshlrev_b32 v61, 5, v61
    v_lshlrev_b32 v60, 7, v60
    v_and_b32 v62, 3, v0
    v_lshlrev_b32 v62, 3, v62
    v_add3_u32 v41, v60, v61, v62
    s_lshl_b32 s51, s38, 12
    s_add_u32 s51, s51, 122880
    v_add_u32 v40, s51, v40
    v_add_u32 v41, s51, v41
    s_waitcnt vmcnt(0)
    ds_read_b64_tr_b16 v[44:45], v40 offset:0
    ds_read_b64_tr_b16 v[46:47], v40 offset:1024
    ds_read_b64_tr_b16 v[48:49], v41 offset:0
    ds_read_b64_tr_b16 v[50:51], v41 offset:1024
    s_waitcnt lgkmcnt(0)
    buffer_store_dwordx4 v[44:47], v1, s[24:27], s89 offen offset:0 sc1
    buffer_store_dwordx4 v[48:51], v1, s[24:27], s89 offen offset:1024 sc1
    s_cmp_eq_u32 s38, 4
    s_cbranch_scc1 L_p2f_skip
    v_lshrrev_b32 v16, 3, v0
    v_bfe_u32 v17, v0, 4, 2
    v_and_b32 v18, 1, v17
    v_lshlrev_b32 v18, 1, v18
    v_lshrrev_b32 v17, 1, v17
    v_or_b32 v17, v17, v18
    v_bfe_u32 v18, v0, 1, 2
    v_xor_b32 v17, v17, v18
    v_lshlrev_b32 v17, 5, v17
    v_and_b32 v18, 1, v0
    v_lshl_add_u32 v17, v18, 4, v17
    s_mov_b32 s49, 2752
    v_mul_lo_u32 v18, v16, s49
    v_add_u32 v3, v18, v17
    s_mov_b32 s49, 1024
    v_mul_lo_u32 v18, v16, s49
    v_add_u32 v4, v18, v17
    s_sub_u32 s50, s38, 5
    s_mul_i32 s88, s36, 44032
    s_lshl_b32 s51, s98, 5
    s_add_u32 s88, s88, s51
    s_lshl_b32 s51, s50, 7
    s_add_u32 s88, s88, s51
    s_mul_i32 s92, s37, 196608
    s_lshl_b32 s51, s36, 11
    s_add_u32 s92, s92, s51
    s_lshl_b32 s51, s50, 16
    s_add_u32 s92, s92, s51
    s_add_u32 s92, s92, 23068672
    s_lshl_b32 s52, s38, 12
    s_add_u32 m0, s52, 122880
    s_add_u32 s49, s88, 0
    buffer_load_dwordx4 v3, s[16:19], s49 offen lds
    s_lshl_b32 s52, s38, 12
    s_add_u32 m0, s52, 123904
    s_add_u32 s49, s88, 22016
    buffer_load_dwordx4 v3, s[16:19], s49 offen lds
    s_lshl_b32 s50, s50, 5
    s_add_u32 s50, s50, s36
    s_lshl_b32 s89, s50, 14
    s_lshl_b32 s49, s37, 7
    s_add_u32 s89, s89, s49
    s_lshl_b32 s93, s50, 11
    s_mul_i32 s49, s37, 180224
    s_add_u32 s93, s93, s49
    s_add_u32 s93, s93, 26214400
    s_cmp_lt_u32 s50, 86
    s_cselect_b32 s93, s93, 0x7ffff000
    s_lshl_b32 s52, s38, 12
    s_add_u32 m0, s52, 124928
    s_add_u32 s49, s89, 0
    buffer_load_dwordx4 v4, s[20:23], s49 offen lds
    s_lshl_b32 s52, s38, 12
    s_add_u32 m0, s52, 125952
    s_add_u32 s49, s89, 8192
    buffer_load_dwordx4 v4, s[20:23], s49 offen lds
L_p2f_skip:
    s_mul_i32 s49, s37, 196608
    s_add_u32 s49, s49, s48
    s_add_u32 s55, s49, 20971520
    s_add_u32 s56, s49, 23068672
    s_lshl_b32 s57, s37, 16
    s_add_u32 s57, s57, s48
    s_add_u32 s57, s57, 25165824
    s_mul_i32 s100, s37, 180224
    s_add_u32 s100, s100, s48
    s_add_u32 s100, s100, 26214400
    v_add_u32 v11, s48, v1
    v_add_u32 v12, 0x10000, v11
    v_add_u32 v13, 0x20000, v11
    s_and_b32 s49, s39, 1
    s_lshr_b32 s50, s39, 1
    s_lshl_b32 s53, s36, 16
    s_lshl_b32 s51, s49, 15
    s_add_u32 s53, s53, s51
    s_lshl_b32 s51, s50, 10
    s_add_u32 s53, s53, s51
    s_add_u32 s53, s53, 1048576
    s_mov_b32 s42, s49
    s_sub_i32 s62, s36, 4
    s_lshl_b32 s62, s62, 3
    s_add_i32 s62, s62, s37
    s_lshl_b32 s62, s62, 14
    s_add_i32 s62, s62, s48
    s_add_i32 s62, s62, 9437184
    s_lshl_b32 s49, s36, 7
    v_and_b32 v16, 7, v0
    v_lshlrev_b32 v16, 2, v16
    v_add_u32 v6, s49, v16
    s_lshl_b32 s50, s37, 2
    s_add_u32 s49, s49, s50
    v_mov_b32 v7, s49
    v_lshlrev_b32 v8, 6, v0
    v_and_b32 v16, 31, v0
    v_lshlrev_b32 v16, 2, v16
    v_lshrrev_b32 v17, 5, v0
    v_lshl_add_u32 v16, v17, 8, v16
    s_lshl_b32 s49, s42, 7
    s_add_u32 s49, s49, 155648
    v_add_u32 v9, s49, v16
    s_mov_b32 s82, 989855744
    s_mov_b32 s83, 925353388
    v_lshlrev_b32 v10, 7, v0
    v_mov_b32 v20, 162820
    v_mov_b32 v21, 0
    ds_write_b32 v20, v21
    s_cmp_eq_u32 s38, 4
    s_cbranch_scc1 L_l_w40
    s_cmp_eq_u32 s38, 7
    s_cbranch_scc1 L_l_w42
    s_waitcnt vmcnt(4)
L_l_w42:
    s_waitcnt lgkmcnt(0)
    s_branch L_l_w41
L_l_w40:
    s_waitcnt vmcnt(0) lgkmcnt(0)
L_l_w41:
    s_add_u32 s87, s87, 16
    s_barrier
    s_cmp_lg_u32 s38, 4
    s_cbranch_scc1 L_sig_skip0
    s_getreg_b32 s50, hwreg(HW_REG_XCC_ID, 0, 3)
    s_add_u32 s74, s87, 1
    s_lshl_b32 s51, s37, 5
    s_add_u32 s51, s51, s36
    s_lshl_b32 s51, s51, 7
    s_add_u32 s51, s51, 29360128
    v_mov_b32 v20, s74
    v_mov_b32 v21, s50
    v_mov_b32 v22, s51
    s_mov_b64 s[70:71], exec
    s_mov_b64 exec, 1
    buffer_store_dwordx2 v[20:21], v22, s[24:27], 0 offen sc1
    s_mov_b64 exec, s[70:71]
L_sig_skip0:
    s_cmp_eq_u32 s38, 4
    s_cbranch_scc1 L_p2r_skip
    s_waitcnt vmcnt(0)
    ds_read_b64_tr_b16 v[212:213], v40 offset:0
    ds_read_b64_tr_b16 v[214:215], v40 offset:1024
    ds_read_b64_tr_b16 v[216:217], v41 offset:0
    ds_read_b64_tr_b16 v[218:219], v41 offset:1024
    ds_read_b64_tr_b16 v[220:221], v40 offset:2048
    ds_read_b64_tr_b16 v[222:223], v40 offset:3072
    ds_read_b64_tr_b16 v[224:225], v41 offset:2048
    ds_read_b64_tr_b16 v[226:227], v41 offset:3072
    s_waitcnt lgkmcnt(0)
    buffer_store_dwordx4 v[212:215], v1, s[24:27], s92 offen offset:0 sc1
    buffer_store_dwordx4 v[216:219], v1, s[24:27], s92 offen offset:1024 sc1
L_p2r_skip:
    s_cmp_lg_u32 s38, 4
    s_cbranch_scc1 L_sig_skip
    s_add_u32 s74, s87, 1
    v_and_b32 v22, 31, v0
    s_lshl_b32 s51, s37, 5
    v_add_u32 v22, s51, v22
    v_lshlrev_b32 v22, 7, v22
    v_add_u32 v22, 29360128, v22
    s_mov_b32 exec_hi, 0
    s_mov_b32 s60, 400000
L_sig:
    buffer_load_dword v23, v22, s[24:27], 0 offen sc1
    s_waitcnt vmcnt(0)
    v_subrev_u32 v23, s74, v23
    v_cmp_le_u32 vcc, 8, v23
    s_sub_u32 s60, s60, 1
    s_cbranch_scc1 L_sig_x
    s_cbranch_vccnz L_sig
L_sig_x:
    s_mov_b64 exec, -1
L_sig_skip:
    s_barrier
    v_bfe_u32 v89, v0, 4, 1
    v_and_b32 v90, 15, v0
    v_cmp_eq_u32 s[70:71], v89, v90
    v_mov_b32 v91, 0x3f803f80
    v_mov_b32 v92, 0
    s_nop 0
    v_cndmask_b32 v84, v92, v91, s[70:71]
    v_cndmask_b32 v85, v92, v91, s[70:71]
    v_cndmask_b32 v86, v92, v91, s[70:71]
    v_cndmask_b32 v87, v92, v91, s[70:71]
    s_lshl_b32 s50, s39, 7
    s_add_u32 s50, s50, 161280
    v_lshlrev_b32 v88, 2, v0
    v_add_u32 v88, s50, v88
    s_add_u32 m0, s48, 65536
    s_add_u32 s49, s55, 0
    buffer_load_dwordx4 v1, s[24:27], s49 offen sc1 lds
    s_add_u32 m0, s48, 69632
    s_add_u32 s49, s55, 4096
    buffer_load_dwordx4 v1, s[24:27], s49 offen sc1 lds
    s_add_u32 m0, s48, 73728
    s_add_u32 s49, s55, 8192
    buffer_load_dwordx4 v1, s[24:27], s49 offen sc1 lds
    s_add_u32 m0, s48, 77824
    s_add_u32 s49, s55, 12288
    buffer_load_dwordx4 v1, s[24:27], s49 offen sc1 lds
    s_add_u32 m0, s48, 81920
    s_add_u32 s49, s55, 16384
    buffer_load_dwordx4 v1, s[24:27], s49 offen sc1 lds
    s_add_u32 m0, s48, 86016
    s_add_u32 s49, s55, 20480
    buffer_load_dwordx4 v1, s[24:27], s49 offen sc1 lds
    s_add_u32 m0, s48, 90112
    s_add_u32 s49, s55, 24576
    buffer_load_dwordx4 v1, s[24:27], s49 offen sc1 lds
    s_add_u32 m0, s48, 94208
    s_add_u32 s49, s55, 28672
    buffer_load_dwordx4 v1, s[24:27], s49 offen sc1 lds
    s_add_u32 m0, s48, 98304
    s_add_u32 s49, s55, 32768
    buffer_load_dwordx4 v1, s[24:27], s49 offen sc1 lds
    s_add_u32 m0, s48, 102400
    s_add_u32 s49, s55, 36864
    buffer_load_dwordx4 v1, s[24:27], s49 offen sc1 lds
    s_add_u32 m0, s48, 106496
    s_add_u32 s49, s55, 40960
    buffer_load_dwordx4 v1, s[24:27], s49 offen sc1 lds
    s_add_u32 m0, s48, 110592
    s_add_u32 s49, s55, 45056
    buffer_load_dwordx4 v1, s[24:27], s49 offen sc1 lds
    s_waitcnt vmcnt(10)
    s_barrier
    s_cmp_ge_u32 s39, 2
    s_cbranch_scc1 L_p1a_cs0_353
    ds_read_b128 v[64:67], v12 offset:0
    ds_read_b128 v[68:71], v12 offset:2048
    ds_read_b128 v[72:75], v12 offset:4096
    ds_read_b128 v[76:79], v12 offset:6144
L_p1a_cs0_353:
    s_add_u32 m0, s48, 114688
    s_add_u32 s49, s55, 49152
    buffer_load_dwordx4 v1, s[24:27], s49 offen sc1 lds
    s_add_u32 m0, s48, 118784
    s_add_u32 s49, s55, 53248
    buffer_load_dwordx4 v1, s[24:27], s49 offen sc1 lds
    s_waitcnt vmcnt(10)
    s_barrier
    s_cmp_lg_u32 s38, 4
    s_cbranch_scc1 L_sig2_skip
    s_add_u32 s74, s87, 2
    s_lshl_b32 s51, s37, 5
    s_add_u32 s51, s51, s36
    s_lshl_b32 s51, s51, 7
    s_add_u32 s51, s51, 29360128
    v_mov_b32 v20, s74
    v_mov_b32 v22, s51
    s_mov_b64 s[70:71], exec
    s_mov_b64 exec, 1
    buffer_store_dword v20, v22, s[24:27], 0 offen sc1
    s_mov_b64 exec, s[70:71]
L_sig2_skip:
    s_cmp_ge_u32 s39, 2
    s_cbranch_scc1 L_p1a_cs1_382
    s_waitcnt lgkmcnt(0)
    v_mfma_f32_16x16x32_bf16 v[80:83], v[84:87], v[64:67], 0
    v_mfma_f32_16x16x32_bf16 v[80:83], v[84:87], v[68:71], v[80:83]
    v_mfma_f32_16x16x32_bf16 v[80:83], v[84:87], v[72:75], v[80:83]
    v_mfma_f32_16x16x32_bf16 v[80:83], v[84:87], v[76:79], v[80:83]
    ds_read_b128 v[64:67], v12 offset:8192
    ds_read_b128 v[68:71], v12 offset:10240
    ds_read_b128 v[72:75], v12 offset:12288
    ds_read_b128 v[76:79], v12 offset:14336
L_p1a_cs1_382:
    s_add_u32 m0, s48, 122880
    s_add_u32 s49, s55, 57344
    buffer_load_dwordx4 v1, s[24:27], s49 offen sc1 lds
    s_add_u32 m0, s48, 126976
    s_add_u32 s49, s55, 61440
    buffer_load_dwordx4 v1, s[24:27], s49 offen sc1 lds
    s_waitcnt vmcnt(10)
    s_barrier
    s_cmp_ge_u32 s39, 2
    s_cbranch_scc1 L_p1a_cs2_402
    s_waitcnt lgkmcnt(0)
    v_mfma_f32_16x16x32_bf16 v[80:83], v[84:87], v[64:67], v[80:83]
    v_mfma_f32_16x16x32_bf16 v[80:83], v[84:87], v[68:71], v[80:83]
    v_mfma_f32_16x16x32_bf16 v[80:83], v[84:87], v[72:75], v[80:83]
    v_mfma_f32_16x16x32_bf16 v[80:83], v[84:87], v[76:79], v[80:83]
    ds_read_b128 v[64:67], v12 offset:16384
    ds_read_b128 v[68:71], v12 offset:18432
    ds_read_b128 v[72:75], v12 offset:20480
    ds_read_b128 v[76:79], v12 offset:22528
L_p1a_cs2_402:
    s_add_u32 m0, s48, 131072
    s_add_u32 s49, s55, 65536
    buffer_load_dwordx4 v1, s[24:27], s49 offen sc1 lds
    s_add_u32 m0, s48, 135168
    s_add_u32 s49, s55, 69632
    buffer_load_dwordx4 v1, s[24:27], s49 offen sc1 lds
    s_waitcnt vmcnt(10)
    s_barrier
    s_cmp_ge_u32 s39, 2
    s_cbranch_scc1 L_p1a_cs3_422
    s_waitcnt lgkmcnt(0)
    v_mfma_f32_16x16x32_bf16 v[80:83], v[84:87], v[64:67], v[80:83]
    v_mfma_f32_16x16x32_bf16 v[80:83], v[84:87], v[68:71], v[80:83]
    v_mfma_f32_16x16x32_bf16 v[80:83], v[84:87], v[72:75], v[80:83]
    v_mfma_f32_16x16x32_bf16 v[80:83], v[84:87], v[76:79], v[80:83]
    ds_read_b128 v[64:67], v12 offset:24576
    ds_read_b128 v[68:71], v12 offset:26624
    ds_read_b128 v[72:75], v12 offset:28672
    ds_read_b128 v[76:79], v12 offset:30720
L_p1a_cs3_422:
    s_add_u32 m0, s48, 139264
    s_add_u32 s49, s55, 73728
    buffer_load_dwordx4 v1, s[24:27], s49 offen sc1 lds
    s_add_u32 m0, s48, 143360
    s_add_u32 s49, s55, 77824
    buffer_load_dwordx4 v1, s[24:27], s49 offen sc1 lds
    s_waitcnt vmcnt(10)
    s_barrier
    s_cmp_ge_u32 s39, 2
    s_cbranch_scc1 L_p1a_cs4_442
    s_waitcnt lgkmcnt(0)
    v_mfma_f32_16x16x32_bf16 v[80:83], v[84:87], v[64:67], v[80:83]
    v_mfma_f32_16x16x32_bf16 v[80:83], v[84:87], v[68:71], v[80:83]
    v_mfma_f32_16x16x32_bf16 v[80:83], v[84:87], v[72:75], v[80:83]
    v_mfma_f32_16x16x32_bf16 v[80:83], v[84:87], v[76:79], v[80:83]
    ds_read_b128 v[64:67], v12 offset:32768
    ds_read_b128 v[68:71], v12 offset:34816
    ds_read_b128 v[72:75], v12 offset:36864
    ds_read_b128 v[76:79], v12 offset:38912
L_p1a_cs4_442:
    s_add_u32 m0, s48, 147456
    s_add_u32 s49, s55, 81920
    buffer_load_dwordx4 v1, s[24:27], s49 offen sc1 lds
    s_add_u32 m0, s48, 151552
    s_add_u32 s49, s55, 86016
    buffer_load_dwordx4 v1, s[24:27], s49 offen sc1 lds
    s_waitcnt vmcnt(10)
    s_barrier
    s_cmp_ge_u32 s39, 2
    s_cbranch_scc1 L_p1a_cs5_462
    s_waitcnt lgkmcnt(0)
    v_mfma_f32_16x16x32_bf16 v[80:83], v[84:87], v[64:67], v[80:83]
    v_mfma_f32_16x16x32_bf16 v[80:83], v[84:87], v[68:71], v[80:83]
    v_mfma_f32_16x16x32_bf16 v[80:83], v[84:87], v[72:75], v[80:83]
    v_mfma_f32_16x16x32_bf16 v[80:83], v[84:87], v[76:79], v[80:83]
    ds_read_b128 v[64:67], v12 offset:40960
    ds_read_b128 v[68:71], v12 offset:43008
    ds_read_b128 v[72:75], v12 offset:45056
    ds_read_b128 v[76:79], v12 offset:47104
L_p1a_cs5_462:
    s_add_u32 m0, s48, 65536
    s_add_u32 s49, s55, 90112
    buffer_load_dwordx4 v1, s[24:27], s49 offen sc1 lds
    s_add_u32 m0, s48, 69632
    s_add_u32 s49, s55, 94208
    buffer_load_dwordx4 v1, s[24:27], s49 offen sc1 lds
    s_waitcnt vmcnt(10)
    s_barrier
    s_cmp_ge_u32 s39, 2
    s_cbranch_scc1 L_p1a_cs6_482
    s_waitcnt lgkmcnt(0)
    v_mfma_f32_16x16x32_bf16 v[80:83], v[84:87], v[64:67], v[80:83]
    v_mfma_f32_16x16x32_bf16 v[80:83], v[84:87], v[68:71], v[80:83]
    v_mfma_f32_16x16x32_bf16 v[80:83], v[84:87], v[72:75], v[80:83]
    v_mfma_f32_16x16x32_bf16 v[80:83], v[84:87], v[76:79], v[80:83]
    ds_read_b128 v[64:67], v12 offset:49152
    ds_read_b128 v[68:71], v12 offset:51200
    ds_read_b128 v[72:75], v12 offset:53248
    ds_read_b128 v[76:79], v12 offset:55296
L_p1a_cs6_482:
    s_add_u32 m0, s48, 73728
    s_add_u32 s49, s55, 98304
    buffer_load_dwordx4 v1, s[24:27], s49 offen sc1 lds
    s_add_u32 m0, s48, 77824
    s_add_u32 s49, s55, 102400
    buffer_load_dwordx4 v1, s[24:27], s49 offen sc1 lds
    s_waitcnt vmcnt(10)
    s_barrier
    s_cmp_ge_u32 s39, 2
    s_cbranch_scc1 L_p1a_cs7_502
    s_waitcnt lgkmcnt(0)
    v_mfma_f32_16x16x32_bf16 v[80:83], v[84:87], v[64:67], v[80:83]
    v_mfma_f32_16x16x32_bf16 v[80:83], v[84:87], v[68:71], v[80:83]
    v_mfma_f32_16x16x32_bf16 v[80:83], v[84:87], v[72:75], v[80:83]
    v_mfma_f32_16x16x32_bf16 v[80:83], v[84:87], v[76:79], v[80:83]
    ds_read_b128 v[64:67], v12 offset:57344
    ds_read_b128 v[68:71], v12 offset:59392
    ds_read_b128 v[72:75], v12 offset:61440
    ds_read_b128 v[76:79], v12 offset:63488
L_p1a_cs7_502:
    s_add_u32 m0, s48, 81920
    s_add_u32 s49, s55, 106496
    buffer_load_dwordx4 v1, s[24:27], s49 offen sc1 lds
    s_add_u32 m0, s48, 86016
    s_add_u32 s49, s55, 110592
    buffer_load_dwordx4 v1, s[24:27], s49 offen sc1 lds
    s_waitcnt vmcnt(10)
    s_barrier
    v_and_b32 v24, 7, v0
    v_lshlrev_b32 v24, 5, v24
    v_add_u32 v24, s36, v24
    v_lshlrev_b32 v24, 7, v24
    v_add_u32 v24, 29360128, v24
    buffer_load_dwordx2 v[28:29], v24, s[24:27], 0 offen sc1
    s_cmp_ge_u32 s39, 2
    s_cbranch_scc1 L_p1a_cs8_528
    s_waitcnt lgkmcnt(0)
    v_mfma_f32_16x16x32_bf16 v[80:83], v[84:87], v[64:67], v[80:83]
    v_mfma_f32_16x16x32_bf16 v[80:83], v[84:87], v[68:71], v[80:83]
    v_mfma_f32_16x16x32_bf16 v[80:83], v[84:87], v[72:75], v[80:83]
    v_mfma_f32_16x16x32_bf16 v[80:83], v[84:87], v[76:79], v[80:83]
    s_nop 7
    s_mov_b64 exec, s[78:79]
    ds_write_b32 v88, v80 offset:0
    ds_write_b32 v88, v81 offset:64
    s_mov_b64 exec, -1
    ds_read_b128 v[64:67], v13 offset:0
    ds_read_b128 v[68:71], v13 offset:2048
    ds_read_b128 v[72:75], v13 offset:4096
    ds_read_b128 v[76:79], v13 offset:6144
L_p1a_cs8_528:
    s_add_u32 m0, s48, 90112
    s_add_u32 s49, s55, 114688
    buffer_load_dwordx4 v1, s[24:27], s49 offen sc1 lds
    s_add_u32 m0, s48, 94208
    s_add_u32 s49, s55, 118784
    buffer_load_dwordx4 v1, s[24:27], s49 offen sc1 lds
    s_waitcnt vmcnt(11)
    s_waitcnt lgkmcnt(0)
    s_barrier
    s_cmp_ge_u32 s39, 2
    s_cbranch_scc1 L_p1a_cs9_554
    s_waitcnt lgkmcnt(0)
    v_mfma_f32_16x16x32_bf16 v[80:83], v[84:87], v[64:67], 0
    v_mfma_f32_16x16x32_bf16 v[80:83], v[84:87], v[68:71], v[80:83]
    v_mfma_f32_16x16x32_bf16 v[80:83], v[84:87], v[72:75], v[80:83]
    v_mfma_f32_16x16x32_bf16 v[80:83], v[84:87], v[76:79], v[80:83]
    ds_read_b128 v[64:67], v13 offset:8192
    ds_read_b128 v[68:71], v13 offset:10240
    ds_read_b128 v[72:75], v13 offset:12288
    ds_read_b128 v[76:79], v13 offset:14336
L_p1a_cs9_554:
    s_add_u32 m0, s48, 98304
    s_add_u32 s49, s55, 122880
    buffer_load_dwordx4 v1, s[24:27], s49 offen sc1 lds
    s_add_u32 m0, s48, 102400
    s_add_u32 s49, s55, 126976
    buffer_load_dwordx4 v1, s[24:27], s49 offen sc1 lds
    s_waitcnt vmcnt(11)
    s_barrier
    s_cmp_ge_u32 s39, 2
    s_cbranch_scc1 L_p1a_cs10_574
    s_waitcnt lgkmcnt(0)
    v_mfma_f32_16x16x32_bf16 v[80:83], v[84:87], v[64:67], v[80:83]
    v_mfma_f32_16x16x32_bf16 v[80:83], v[84:87], v[68:71], v[80:83]
    v_mfma_f32_16x16x32_bf16 v[80:83], v[84:87], v[72:75], v[80:83]
    v_mfma_f32_16x16x32_bf16 v[80:83], v[84:87], v[76:79], v[80:83]
    ds_read_b128 v[64:67], v13 offset:16384
    ds_read_b128 v[68:71], v13 offset:18432
    ds_read_b128 v[72:75], v13 offset:20480
    ds_read_b128 v[76:79], v13 offset:22528
L_p1a_cs10_574:
    s_add_u32 m0, s48, 0
    s_add_u32 s49, s55, 131072
    buffer_load_dwordx4 v1, s[24:27], s49 offen sc1 lds
    s_add_u32 m0, s48, 4096
    s_add_u32 s49, s55, 135168
    buffer_load_dwordx4 v1, s[24:27], s49 offen sc1 lds
    s_waitcnt vmcnt(11)
    s_barrier
    s_cmp_ge_u32 s39, 2
    s_cbranch_scc1 L_p1a_cs11_594
    s_waitcnt lgkmcnt(0)
    v_mfma_f32_16x16x32_bf16 v[80:83], v[84:87], v[64:67], v[80:83]
    v_mfma_f32_16x16x32_bf16 v[80:83], v[84:87], v[68:71], v[80:83]
    v_mfma_f32_16x16x32_bf16 v[80:83], v[84:87], v[72:75], v[80:83]
    v_mfma_f32_16x16x32_bf16 v[80:83], v[84:87], v[76:79], v[80:83]
    ds_read_b128 v[64:67], v12 offset:0
    ds_read_b128 v[68:71], v12 offset:2048
    ds_read_b128 v[72:75], v12 offset:4096
    ds_read_b128 v[76:79], v12 offset:6144
L_p1a_cs11_594:
    s_add_u32 m0, s48, 8192
    s_add_u32 s49, s55, 139264
    buffer_load_dwordx4 v1, s[24:27], s49 offen sc1 lds
    s_add_u32 m0, s48, 12288
    s_add_u32 s49, s55, 143360
    buffer_load_dwordx4 v1, s[24:27], s49 offen sc1 lds
    s_waitcnt vmcnt(11)
    s_barrier
    v_and_b32 v26, 31, v0
    s_lshl_b32 s51, s37, 5
    v_add_u32 v26, s51, v26
    v_lshlrev_b32 v26, 7, v26
    v_add_u32 v26, 29360128, v26
    s_mov_b32 exec_hi, 0
    buffer_load_dword v27, v26, s[24:27], 0 offen sc1
    s_mov_b64 exec, -1
    s_cmp_ge_u32 s39, 2
    s_cbranch_scc1 L_p1a_cs12_622
    s_waitcnt lgkmcnt(0)
    v_mfma_f32_16x16x32_bf16 v[80:83], v[84:87], v[64:67], v[80:83]
    v_mfma_f32_16x16x32_bf16 v[80:83], v[84:87], v[68:71], v[80:83]
    v_mfma_f32_16x16x32_bf16 v[80:83], v[84:87], v[72:75], v[80:83]
    v_mfma_f32_16x16x32_bf16 v[80:83], v[84:87], v[76:79], v[80:83]
    ds_read_b128 v[64:67], v12 offset:8192
    ds_read_b128 v[68:71], v12 offset:10240
    ds_read_b128 v[72:75], v12 offset:12288
    ds_read_b128 v[76:79], v12 offset:14336
L_p1a_cs12_622:
    s_add_u32 m0, s48, 16384
    s_add_u32 s49, s55, 147456
    buffer_load_dwordx4 v1, s[24:27], s49 offen sc1 lds
    s_add_u32 m0, s48, 20480
    s_add_u32 s49, s55, 151552
    buffer_load_dwordx4 v1, s[24:27], s49 offen sc1 lds
    s_waitcnt vmcnt(12)
    s_barrier
    s_waitcnt vmcnt(11)
    s_cmp_lg_u32 s38, 4
    s_cbranch_scc1 L_die_skip
    s_add_u32 s74, s87, 1
    s_mov_b32 s60, 400000
L_die_loop:
    v_subrev_u32 v28, s74, v28
    v_cmp_le_u32 vcc, 8, v28
    s_sub_u32 s60, s60, 1
    s_cbranch_scc1 L_die_x
    s_cbranch_vccz L_die_x
    buffer_load_dwordx2 v[28:29], v24, s[24:27], 0 offen sc1
    s_waitcnt vmcnt(0)
    s_branch L_die_loop
L_die_x:
    s_getreg_b32 s51, hwreg(HW_REG_XCC_ID, 0, 3)
    v_cmp_ne_u32 vcc, s51, v29
    s_nop 4
    s_cmp_eq_u64 vcc, 0
    s_cselect_b32 s50, 1, 0
    v_mov_b32 v28, s50
    v_mov_b32 v29, 162816
    ds_write_b32 v29, v28
    s_waitcnt lgkmcnt(0)
L_die_skip:
    s_cmp_ge_u32 s39, 2
    s_cbranch_scc1 L_p1a_cs13_667
    s_waitcnt lgkmcnt(0)
    v_mfma_f32_16x16x32_bf16 v[80:83], v[84:87], v[64:67], v[80:83]
    v_mfma_f32_16x16x32_bf16 v[80:83], v[84:87], v[68:71], v[80:83]
    v_mfma_f32_16x16x32_bf16 v[80:83], v[84:87], v[72:75], v[80:83]
    v_mfma_f32_16x16x32_bf16 v[80:83], v[84:87], v[76:79], v[80:83]
    ds_read_b128 v[64:67], v12 offset:16384
    ds_read_b128 v[68:71], v12 offset:18432
    ds_read_b128 v[72:75], v12 offset:20480
    ds_read_b128 v[76:79], v12 offset:22528
L_p1a_cs13_667:
    s_add_u32 m0, s48, 24576
    s_add_u32 s49, s55, 155648
    buffer_load_dwordx4 v1, s[24:27], s49 offen sc1 lds
    s_add_u32 m0, s48, 28672
    s_add_u32 s49, s55, 159744
    buffer_load_dwordx4 v1, s[24:27], s49 offen sc1 lds
    s_waitcnt vmcnt(11)
    s_barrier
    s_cmp_ge_u32 s39, 2
    s_cbranch_scc1 L_p1a_cs14_687
    s_waitcnt lgkmcnt(0)
    v_mfma_f32_16x16x32_bf16 v[80:83], v[84:87], v[64:67], v[80:83]
    v_mfma_f32_16x16x32_bf16 v[80:83], v[84:87], v[68:71], v[80:83]
    v_mfma_f32_16x16x32_bf16 v[80:83], v[84:87], v[72:75], v[80:83]
    v_mfma_f32_16x16x32_bf16 v[80:83], v[84:87], v[76:79], v[80:83]
    ds_read_b128 v[64:67], v12 offset:24576
    ds_read_b128 v[68:71], v12 offset:26624
    ds_read_b128 v[72:75], v12 offset:28672
    ds_read_b128 v[76:79], v12 offset:30720
L_p1a_cs14_687:
    s_add_u32 m0, s48, 40960
    s_add_u32 s49, s55, 163840
    buffer_load_dwordx4 v1, s[24:27], s49 offen sc1 lds
    s_add_u32 m0, s48, 45056
    s_add_u32 s49, s55, 167936
    buffer_load_dwordx4 v1, s[24:27], s49 offen sc1 lds
    s_waitcnt vmcnt(11)
    s_barrier
    s_cmp_ge_u32 s39, 2
    s_cbranch_scc1 L_p1a_cs15_707
    s_waitcnt lgkmcnt(0)
    v_mfma_f32_16x16x32_bf16 v[80:83], v[84:87], v[64:67], v[80:83]
    v_mfma_f32_16x16x32_bf16 v[80:83], v[84:87], v[68:71], v[80:83]
    v_mfma_f32_16x16x32_bf16 v[80:83], v[84:87], v[72:75], v[80:83]
    v_mfma_f32_16x16x32_bf16 v[80:83], v[84:87], v[76:79], v[80:83]
    ds_read_b128 v[64:67], v12 offset:32768
    ds_read_b128 v[68:71], v12 offset:34816
    ds_read_b128 v[72:75], v12 offset:36864
    ds_read_b128 v[76:79], v12 offset:38912
L_p1a_cs15_707:
    s_add_u32 m0, s48, 49152
    s_add_u32 s49, s55, 172032
    buffer_load_dwordx4 v1, s[24:27], s49 offen sc1 lds
    s_add_u32 m0, s48, 53248
    s_add_u32 s49, s55, 176128
    buffer_load_dwordx4 v1, s[24:27], s49 offen sc1 lds
    s_waitcnt vmcnt(11)
    s_barrier
    s_cmp_ge_u32 s39, 2
    s_cbranch_scc1 L_p1a_cs16_727
    s_waitcnt lgkmcnt(0)
    v_mfma_f32_16x16x32_bf16 v[80:83], v[84:87], v[64:67], v[80:83]
    v_mfma_f32_16x16x32_bf16 v[80:83], v[84:87], v[68:71], v[80:83]
    v_mfma_f32_16x16x32_bf16 v[80:83], v[84:87], v[72:75], v[80:83]
    v_mfma_f32_16x16x32_bf16 v[80:83], v[84:87], v[76:79], v[80:83]
    s_nop 7
    s_mov_b64 exec, s[78:79]
    ds_write_b32 v88, v80 offset:256
    ds_write_b32 v88, v81 offset:320
    s_mov_b64 exec, -1
    ds_read_b128 v[64:67], v11 offset:0
    ds_read_b128 v[68:71], v11 offset:2048
    ds_read_b128 v[72:75], v11 offset:4096
    ds_read_b128 v[76:79], v11 offset:6144
L_p1a_cs16_727:
    s_add_u32 m0, s48, 57344
    s_add_u32 s49, s55, 180224
    buffer_load_dwordx4 v1, s[24:27], s49 offen sc1 lds
    s_add_u32 m0, s48, 61440
    s_add_u32 s49, s55, 184320
    buffer_load_dwordx4 v1, s[24:27], s49 offen sc1 lds
    s_waitcnt vmcnt(11)
    s_waitcnt lgkmcnt(0)
    s_barrier
    s_waitcnt vmcnt(10)
    s_add_u32 s74, s87, 2
    s_mov_b32 exec_hi, 0
    v_subrev_u32 v27, s74, v27
    v_cmp_le_u32 vcc, 8, v27
    s_cbranch_vccz L_s2_ok
    s_mov_b32 s60, 400000
L_s2p:
    buffer_load_dword v27, v26, s[24:27], 0 offen sc1
    s_waitcnt vmcnt(0)
    v_subrev_u32 v27, s74, v27
    v_cmp_le_u32 vcc, 8, v27
    s_sub_u32 s60, s60, 1
    s_cbranch_scc1 L_s2p_x
    s_cbranch_vccnz L_s2p
L_s2p_x:
L_s2_ok:
    s_mov_b64 exec, -1
    s_cmp_ge_u32 s39, 2
    s_cbranch_scc1 L_p1a_cs17_771
    s_waitcnt lgkmcnt(0)
    v_mfma_f32_16x16x32_bf16 v[80:83], v[84:87], v[64:67], 0
    v_mfma_f32_16x16x32_bf16 v[80:83], v[84:87], v[68:71], v[80:83]
    v_mfma_f32_16x16x32_bf16 v[80:83], v[84:87], v[72:75], v[80:83]
    v_mfma_f32_16x16x32_bf16 v[80:83], v[84:87], v[76:79], v[80:83]
    ds_read_b128 v[64:67], v11 offset:8192
    ds_read_b128 v[68:71], v11 offset:10240
    ds_read_b128 v[72:75], v11 offset:12288
    ds_read_b128 v[76:79], v11 offset:14336
L_p1a_cs17_771:
    s_add_u32 m0, s48, 65536
    s_add_u32 s49, s55, 188416
    buffer_load_dwordx4 v1, s[24:27], s49 offen sc1 lds
    s_add_u32 m0, s48, 69632
    s_add_u32 s49, s55, 192512
    buffer_load_dwordx4 v1, s[24:27], s49 offen sc1 lds
    s_waitcnt vmcnt(10)
    s_barrier
    s_cmp_ge_u32 s39, 2
    s_cbranch_scc1 L_p1a_cs18_791
    s_waitcnt lgkmcnt(0)
    v_mfma_f32_16x16x32_bf16 v[80:83], v[84:87], v[64:67], v[80:83]
    v_mfma_f32_16x16x32_bf16 v[80:83], v[84:87], v[68:71], v[80:83]
    v_mfma_f32_16x16x32_bf16 v[80:83], v[84:87], v[72:75], v[80:83]
    v_mfma_f32_16x16x32_bf16 v[80:83], v[84:87], v[76:79], v[80:83]
    ds_read_b128 v[64:67], v11 offset:16384
    ds_read_b128 v[68:71], v11 offset:18432
    ds_read_b128 v[72:75], v11 offset:20480
    ds_read_b128 v[76:79], v11 offset:22528
L_p1a_cs18_791:
    s_add_u32 m0, s48, 90112
    s_add_u32 s49, s57, 0
    buffer_load_dwordx4 v1, s[24:27], s49 offen sc1 lds
    s_add_u32 m0, s48, 94208
    s_add_u32 s49, s57, 4096
    buffer_load_dwordx4 v1, s[24:27], s49 offen sc1 lds
    s_add_u32 m0, s48, 98304
    s_add_u32 s49, s57, 8192
    buffer_load_dwordx4 v1, s[24:27], s49 offen sc1 lds
    s_waitcnt vmcnt(11)
    s_barrier
    s_cmp_ge_u32 s39, 2
    s_cbranch_scc1 L_p1a_cs19_814
    s_waitcnt lgkmcnt(0)
    v_mfma_f32_16x16x32_bf16 v[80:83], v[84:87], v[64:67], v[80:83]
    v_mfma_f32_16x16x32_bf16 v[80:83], v[84:87], v[68:71], v[80:83]
    v_mfma_f32_16x16x32_bf16 v[80:83], v[84:87], v[72:75], v[80:83]
    v_mfma_f32_16x16x32_bf16 v[80:83], v[84:87], v[76:79], v[80:83]
    ds_read_b128 v[64:67], v11 offset:24576
    ds_read_b128 v[68:71], v11 offset:26624
    ds_read_b128 v[72:75], v11 offset:28672
    ds_read_b128 v[76:79], v11 offset:30720
L_p1a_cs19_814:
    s_add_u32 m0, s48, 102400
    s_add_u32 s49, s57, 12288
    buffer_load_dwordx4 v1, s[24:27], s49 offen sc1 lds
    s_add_u32 m0, s48, 106496
    s_add_u32 s49, s57, 16384
    buffer_load_dwordx4 v1, s[24:27], s49 offen sc1 lds
    s_add_u32 m0, s48, 110592
    s_add_u32 s49, s57, 20480
    buffer_load_dwordx4 v1, s[24:27], s49 offen sc1 lds
    s_waitcnt vmcnt(12)
    s_barrier
    s_cmp_ge_u32 s39, 2
    s_cbranch_scc1 L_p1a_cs20_837
    s_waitcnt lgkmcnt(0)
    v_mfma_f32_16x16x32_bf16 v[80:83], v[84:87], v[64:67], v[80:83]
    v_mfma_f32_16x16x32_bf16 v[80:83], v[84:87], v[68:71], v[80:83]
    v_mfma_f32_16x16x32_bf16 v[80:83], v[84:87], v[72:75], v[80:83]
    v_mfma_f32_16x16x32_bf16 v[80:83], v[84:87], v[76:79], v[80:83]
    ds_read_b128 v[64:67], v11 offset:40960
    ds_read_b128 v[68:71], v11 offset:43008
    ds_read_b128 v[72:75], v11 offset:45056
    ds_read_b128 v[76:79], v11 offset:47104
L_p1a_cs20_837:
    s_add_u32 m0, s48, 114688
    s_add_u32 s49, s57, 24576
    buffer_load_dwordx4 v1, s[24:27], s49 offen sc1 lds
    s_add_u32 m0, s48, 118784
    s_add_u32 s49, s57, 28672
    buffer_load_dwordx4 v1, s[24:27], s49 offen sc1 lds
    s_add_u32 m0, s48, 122880
    s_add_u32 s49, s57, 32768
    buffer_load_dwordx4 v1, s[24:27], s49 offen sc1 lds
    s_waitcnt vmcnt(13)
    s_barrier
    s_cmp_ge_u32 s39, 2
    s_cbranch_scc1 L_p1a_cs21_860
    s_waitcnt lgkmcnt(0)
    v_mfma_f32_16x16x32_bf16 v[80:83], v[84:87], v[64:67], v[80:83]
    v_mfma_f32_16x16x32_bf16 v[80:83], v[84:87], v[68:71], v[80:83]
    v_mfma_f32_16x16x32_bf16 v[80:83], v[84:87], v[72:75], v[80:83]
    v_mfma_f32_16x16x32_bf16 v[80:83], v[84:87], v[76:79], v[80:83]
    ds_read_b128 v[64:67], v11 offset:49152
    ds_read_b128 v[68:71], v11 offset:51200
    ds_read_b128 v[72:75], v11 offset:53248
    ds_read_b128 v[76:79], v11 offset:55296
L_p1a_cs21_860:
    s_add_u32 m0, s48, 126976
    s_add_u32 s49, s57, 36864
    buffer_load_dwordx4 v1, s[24:27], s49 offen sc1 lds
    s_add_u32 m0, s48, 131072
    s_add_u32 s49, s57, 40960
    buffer_load_dwordx4 v1, s[24:27], s49 offen sc1 lds
    s_add_u32 m0, s48, 135168
    s_add_u32 s49, s57, 45056
    buffer_load_dwordx4 v1, s[24:27], s49 offen sc1 lds
    s_waitcnt vmcnt(14)
    s_barrier
    s_cmp_lg_u32 s38, 4
    s_cbranch_scc1 L_p1a_kf_skip
    s_lshl_b32 s50, s36, 3
    s_add_u32 s50, s50, s37
    s_lshl_b32 s50, s50, 7
    s_add_u32 s50, s50, 8192
    s_add_u32 s74, s85, 1
    s_add_u32 s74, s74, s87
    v_mov_b32 v21, s74
    v_mov_b32 v22, s50
    s_mov_b64 s[70:71], exec
    s_mov_b64 exec, 1
    buffer_store_dword v21, v22, s[24:27], 0 offen sc1
    s_mov_b64 exec, s[70:71]
L_p1a_kf_skip:
    s_cmp_ge_u32 s39, 2
    s_cbranch_scc1 L_p1a_cs22_898
    s_waitcnt lgkmcnt(0)
    v_mfma_f32_16x16x32_bf16 v[80:83], v[84:87], v[64:67], v[80:83]
    v_mfma_f32_16x16x32_bf16 v[80:83], v[84:87], v[68:71], v[80:83]
    v_mfma_f32_16x16x32_bf16 v[80:83], v[84:87], v[72:75], v[80:83]
    v_mfma_f32_16x16x32_bf16 v[80:83], v[84:87], v[76:79], v[80:83]
    ds_read_b128 v[64:67], v11 offset:57344
    ds_read_b128 v[68:71], v11 offset:59392
    ds_read_b128 v[72:75], v11 offset:61440
    ds_read_b128 v[76:79], v11 offset:63488
L_p1a_cs22_898:
    s_add_u32 m0, s48, 139264
    s_add_u32 s49, s57, 49152
    buffer_load_dwordx4 v1, s[24:27], s49 offen sc1 lds
    s_add_u32 m0, s48, 143360
    s_add_u32 s49, s57, 53248
    buffer_load_dwordx4 v1, s[24:27], s49 offen sc1 lds
    s_add_u32 m0, s48, 147456
    s_add_u32 s49, s57, 57344
    buffer_load_dwordx4 v1, s[24:27], s49 offen sc1 lds
    s_waitcnt vmcnt(15)
    s_barrier
    s_cmp_ge_u32 s39, 2
    s_cbranch_scc1 L_p1a_cs23_921
    s_waitcnt lgkmcnt(0)
    v_mfma_f32_16x16x32_bf16 v[80:83], v[84:87], v[64:67], v[80:83]
    v_mfma_f32_16x16x32_bf16 v[80:83], v[84:87], v[68:71], v[80:83]
    v_mfma_f32_16x16x32_bf16 v[80:83], v[84:87], v[72:75], v[80:83]
    v_mfma_f32_16x16x32_bf16 v[80:83], v[84:87], v[76:79], v[80:83]
    ds_read_b128 v[64:67], v12 offset:0
    ds_read_b128 v[68:71], v12 offset:2048
    ds_read_b128 v[72:75], v12 offset:4096
    ds_read_b128 v[76:79], v12 offset:6144
    s_waitcnt lgkmcnt(0)
    v_mfma_f32_16x16x32_bf16 v[80:83], v[84:87], v[64:67], v[80:83]
    v_mfma_f32_16x16x32_bf16 v[80:83], v[84:87], v[68:71], v[80:83]
    v_mfma_f32_16x16x32_bf16 v[80:83], v[84:87], v[72:75], v[80:83]
    v_mfma_f32_16x16x32_bf16 v[80:83], v[84:87], v[76:79], v[80:83]
    s_nop 7
    s_mov_b64 exec, s[78:79]
    ds_write_b32 v88, v80 offset:512
    ds_write_b32 v88, v81 offset:576
    s_mov_b64 exec, -1
    s_waitcnt lgkmcnt(0)
L_p1a_cs23_921:
    s_add_u32 m0, s48, 151552
    s_add_u32 s49, s57, 61440
    buffer_load_dwordx4 v1, s[24:27], s49 offen sc1 lds
    s_barrier
    s_cmp_lg_u32 s38, 4
    s_cbranch_scc1 L_p1a_kw_skip
    v_and_b32 v22, 3, v0
    v_add_u32 v22, 1, v22
    v_sub_u32 v22, s36, v22
    v_cmp_gt_i32 vcc, 0, v22
    v_mov_b32 v23, s36
    s_nop 1
    v_cndmask_b32 v22, v22, v23, vcc
    v_lshlrev_b32 v22, 3, v22
    v_add_u32 v22, s37, v22
    v_lshlrev_b32 v22, 7, v22
    v_add_u32 v22, 8192, v22
    s_add_u32 s74, s85, 1
    s_add_u32 s74, s74, s87
    s_mov_b32 s60, 400000
L_p1a_kp:
    buffer_load_dword v20, v22, s[24:27], 0 offen sc1
    s_waitcnt vmcnt(0)
    v_subrev_u32 v20, s74, v20
    v_cmp_le_u32 vcc, 8, v20
    s_sub_u32 s60, s60, 1
    s_cbranch_scc1 L_p1a_kp_x
    s_cbranch_vccnz L_p1a_kp
L_p1a_kp_x:
L_p1a_kw_skip:
    s_barrier
L_l_loop:
    s_lshl_b32 s51, s40, 22
    s_add_i32 s51, s51, s62
    s_cmp_lt_u32 s36, 1
    s_cbranch_scc1 L_kv03
    s_add_u32 m0, s48, 24576
    s_add_u32 s49, s51, 393216
    buffer_load_dwordx4 v1, s[24:27], s49 offen sc1 lds
    s_add_u32 m0, s48, 28672
    s_add_u32 s49, s51, 397312
    buffer_load_dwordx4 v1, s[24:27], s49 offen sc1 lds
L_kv03:
    s_cmp_lt_u32 s36, 2
    s_cbranch_scc1 L_kv02
    s_add_u32 m0, s48, 16384
    s_add_u32 s49, s51, 262144
    buffer_load_dwordx4 v1, s[24:27], s49 offen sc1 lds
    s_add_u32 m0, s48, 20480
    s_add_u32 s49, s51, 266240
    buffer_load_dwordx4 v1, s[24:27], s49 offen sc1 lds
L_kv02:
    s_cmp_lt_u32 s36, 3
    s_cbranch_scc1 L_kv01
    s_add_u32 m0, s48, 8192
    s_add_u32 s49, s51, 131072
    buffer_load_dwordx4 v1, s[24:27], s49 offen sc1 lds
    s_add_u32 m0, s48, 12288
    s_add_u32 s49, s51, 135168
    buffer_load_dwordx4 v1, s[24:27], s49 offen sc1 lds
L_kv01:
    s_cmp_lt_u32 s36, 4
    s_cbranch_scc1 L_kv00
    s_add_u32 m0, s48, 0
    s_add_u32 s49, s51, 0
    buffer_load_dwordx4 v1, s[24:27], s49 offen sc1 lds
    s_add_u32 m0, s48, 4096
    s_add_u32 s49, s51, 4096
    buffer_load_dwordx4 v1, s[24:27], s49 offen sc1 lds
L_kv00:
    s_cmp_lg_u32 s40, 0
    s_cbranch_scc1 l_mode
    v_mov_b32 v121, 162816
    ds_read_b32 v121, v121
    s_waitcnt lgkmcnt(0)
    v_readfirstlane_b32 s41, v121
l_mode:
    s_and_b32 s50, s38, 3
    s_lshr_b32 s51, s38, 2
    s_lshl_b32 s52, s50, 10
    s_lshl_b32 s49, s51, 12
    s_add_u32 s52, s52, s49
    v_add_u32 v208, s52, v1
    v_lshrrev_b32 v121, 5, v0
    v_lshlrev_b32 v121, 8, v121
    v_and_b32 v122, 15, v0
    v_lshl_add_u32 v121, v122, 4, v121
    s_add_u32 s52, s52, 40960
    v_add_u32 v209, s52, v121
    s_lshl_b32 s52, s50, 11
    s_lshl_b32 s49, s51, 10
    s_add_u32 s52, s52, s49
    s_add_u32 s52, s52, 81920
    v_add_u32 v210, s52, v1
    s_lshl_b32 s52, s36, 1
    s_add_u32 s52, s52, s51
    s_sub_i32 s72, 8, s52
    s_max_i32 s72, s72, 0
    s_mul_i32 s73, s36, 180224
    s_add_u32 s73, s73, 3145728
    s_lshl_b32 s52, s51, 15
    s_add_u32 s73, s73, s52
    s_lshl_b32 s52, s37, 2
    s_add_u32 s52, s52, s50
    s_lshl_b32 s52, s52, 10
    s_add_u32 s73, s73, s52
    v_and_b32 v121, 31, v0
    v_lshrrev_b32 v122, 5, v0
    v_lshlrev_b32 v122, 2, v122
    v_sub_u32 v121, v121, v122
    v_mov_b32 v120, 4048155338
    v_mov_b32 v122, 0
    v_cmp_le_i32 s[88:89], 0, v121
    s_nop 1
    v_cndmask_b32 v128, v120, v122, s[88:89]
    v_cndmask_b32 v144, v122, v120, s[88:89]
    v_cmp_le_i32 s[90:91], 1, v121
    s_nop 1
    v_cndmask_b32 v129, v120, v122, s[90:91]
    v_cndmask_b32 v145, v122, v120, s[90:91]
    v_cmp_le_i32 s[88:89], 2, v121
    s_nop 1
    v_cndmask_b32 v130, v120, v122, s[88:89]
    v_cndmask_b32 v146, v122, v120, s[88:89]
    v_cmp_le_i32 s[90:91], 3, v121
    s_nop 1
    v_cndmask_b32 v131, v120, v122, s[90:91]
    v_cndmask_b32 v147, v122, v120, s[90:91]
    v_cmp_le_i32 s[88:89], 8, v121
    s_nop 1
    v_cndmask_b32 v132, v120, v122, s[88:89]
    v_cndmask_b32 v148, v122, v120, s[88:89]
    v_cmp_le_i32 s[90:91], 9, v121
    s_nop 1
    v_cndmask_b32 v133, v120, v122, s[90:91]
    v_cndmask_b32 v149, v122, v120, s[90:91]
    v_cmp_le_i32 s[88:89], 10, v121
    s_nop 1
    v_cndmask_b32 v134, v120, v122, s[88:89]
    v_cndmask_b32 v150, v122, v120, s[88:89]
    v_cmp_le_i32 s[90:91], 11, v121
    s_nop 1
    v_cndmask_b32 v135, v120, v122, s[90:91]
    v_cndmask_b32 v151, v122, v120, s[90:91]
    v_cmp_le_i32 s[88:89], 16, v121
    s_nop 1
    v_cndmask_b32 v136, v120, v122, s[88:89]
    v_cndmask_b32 v152, v122, v120, s[88:89]
    v_cmp_le_i32 s[90:91], 17, v121
    s_nop 1
    v_cndmask_b32 v137, v120, v122, s[90:91]
    v_cndmask_b32 v153, v122, v120, s[90:91]
    v_cmp_le_i32 s[88:89], 18, v121
    s_nop 1
    v_cndmask_b32 v138, v120, v122, s[88:89]
    v_cndmask_b32 v154, v122, v120, s[88:89]
    v_cmp_le_i32 s[90:91], 19, v121
    s_nop 1
    v_cndmask_b32 v139, v120, v122, s[90:91]
    v_cndmask_b32 v155, v122, v120, s[90:91]
    v_cmp_le_i32 s[88:89], 24, v121
    s_nop 1
    v_cndmask_b32 v140, v120, v122, s[88:89]
    v_cndmask_b32 v156, v122, v120, s[88:89]
    v_cmp_le_i32 s[90:91], 25, v121
    s_nop 1
    v_cndmask_b32 v141, v120, v122, s[90:91]
    v_cndmask_b32 v157, v122, v120, s[90:91]
    v_cmp_le_i32 s[88:89], 26, v121
    s_nop 1
    v_cndmask_b32 v142, v120, v122, s[88:89]
    v_cndmask_b32 v158, v122, v120, s[88:89]
    v_cmp_le_i32 s[90:91], 27, v121
    s_nop 1
    v_cndmask_b32 v143, v120, v122, s[90:91]
    v_cndmask_b32 v159, v122, v120, s[90:91]
    v_mov_b32 v104, 0x3f803f80
    v_mov_b32 v105, 0x3f803f80
    v_mov_b32 v106, 0x3f803f80
    v_mov_b32 v107, 0x3f803f80
    v_mov_b32 v108, 0x3f803f80
    v_mov_b32 v109, 0x3f803f80
    v_mov_b32 v110, 0x3f803f80
    v_mov_b32 v111, 0x3f803f80
    v_mov_b32 v112, 0x3f803f80
    v_mov_b32 v113, 0x3f803f80
    v_mov_b32 v114, 0x3f803f80
    v_mov_b32 v115, 0x3f803f80
    v_mov_b32 v116, 0x3f803f80
    v_mov_b32 v117, 0x3f803f80
    v_mov_b32 v118, 0x3f803f80
    v_mov_b32 v119, 0x3f803f80
    s_cmp_lg_u32 s38, 4
    s_cbranch_scc1 L_vw_skip
    v_and_b32 v22, 3, v0
    v_add_u32 v22, 1, v22
    v_sub_u32 v22, s36, v22
    v_cmp_gt_i32 vcc, 0, v22
    v_mov_b32 v23, s36
    s_nop 1
    v_cndmask_b32 v22, v22, v23, vcc
    v_lshlrev_b32 v22, 3, v22
    v_add_u32 v22, s37, v22
    v_lshlrev_b32 v22, 7, v22
    v_add_u32 v22, 8196, v22
    s_add_u32 s74, s40, 1
    s_add_u32 s74, s74, s87
    s_mov_b32 s60, 400000
L_vp:
    buffer_load_dword v20, v22, s[24:27], 0 offen sc1
    s_waitcnt vmcnt(0)
    v_subrev_u32 v20, s74, v20
    v_cmp_le_u32 vcc, 8, v20
    s_sub_u32 s60, s60, 1
    s_cbranch_scc1 L_vp_x
    s_cbranch_vccnz L_vp
L_vp_x:
L_vw_skip:
    s_waitcnt vmcnt(0)
    s_barrier
    s_lshl_b32 s51, s40, 22
    s_add_i32 s51, s51, s62
    s_cmp_lt_u32 s36, 1
    s_cbranch_scc1 L_kv13
    s_add_u32 m0, s48, 65536
    s_add_u32 s49, s51, 401408
    buffer_load_dwordx4 v1, s[24:27], s49 offen sc1 lds
    s_add_u32 m0, s48, 69632
    s_add_u32 s49, s51, 405504
    buffer_load_dwordx4 v1, s[24:27], s49 offen sc1 lds
L_kv13:
    s_cmp_lt_u32 s36, 2
    s_cbranch_scc1 L_kv12
    s_add_u32 m0, s48, 57344
    s_add_u32 s49, s51, 270336
    buffer_load_dwordx4 v1, s[24:27], s49 offen sc1 lds
    s_add_u32 m0, s48, 61440
    s_add_u32 s49, s51, 274432
    buffer_load_dwordx4 v1, s[24:27], s49 offen sc1 lds
L_kv12:
    s_cmp_lt_u32 s36, 3
    s_cbranch_scc1 L_kv11
    s_add_u32 m0, s48, 49152
    s_add_u32 s49, s51, 139264
    buffer_load_dwordx4 v1, s[24:27], s49 offen sc1 lds
    s_add_u32 m0, s48, 53248
    s_add_u32 s49, s51, 143360
    buffer_load_dwordx4 v1, s[24:27], s49 offen sc1 lds
L_kv11:
    s_cmp_lt_u32 s36, 4
    s_cbranch_scc1 L_kv10
    s_add_u32 m0, s48, 40960
    s_add_u32 s49, s51, 8192
    buffer_load_dwordx4 v1, s[24:27], s49 offen sc1 lds
    s_add_u32 m0, s48, 45056
    s_add_u32 s49, s51, 12288
    buffer_load_dwordx4 v1, s[24:27], s49 offen sc1 lds
L_kv10:
    s_cmp_lg_u32 s40, 0
    s_cbranch_scc1 L_w2l_skip
    s_cmp_eq_u32 s38, 4
    s_cbranch_scc1 L_w2l_skip
    buffer_store_dwordx4 v[220:223], v1, s[24:27], s93 offen offset:0 sc1
    buffer_store_dwordx4 v[224:227], v1, s[24:27], s93 offen offset:1024 sc1
L_w2l_skip:
    s_cmp_eq_u32 s39, 3
    s_cbranch_scc1 L_ww_e
    s_mul_i32 s50, s37, 196608
    s_and_b32 s51, s36, 3
    s_mul_i32 s51, s51, 22528
    s_add_u32 s50, s50, s51
    s_lshl_b32 s51, s39, 13
    s_add_u32 s50, s50, s51
    s_mov_b32 m0, 163072
    s_add_u32 s52, s50, 23068672
    buffer_load_dword v10, s[24:27], s52 offen lds
L_ww_e:
    s_cmp_eq_u32 s39, 3
    s_cbranch_scc1 L_we_x
    s_mul_i32 s50, s36, 180224
    s_mul_i32 s51, s37, 22528
    s_add_u32 s50, s50, s51
    s_lshl_b32 s51, s39, 13
    s_add_u32 s50, s50, s51
    s_mov_b32 m0, 163072
    s_add_u32 s52, s50, 3145728
    buffer_load_dword v10, s[24:27], s52 offen lds
    s_branch L_we_e
L_we_x:
    s_lshl_b32 s51, s36, 16
    s_lshl_b32 s49, s37, 13
    s_add_u32 s51, s51, s49
    s_mov_b32 m0, 163072
    s_add_u32 s52, s51, 1048576
    buffer_load_dword v10, s[24:27], s52 offen lds
    s_mov_b32 m0, 163072
    s_add_u32 s52, s59, 0
    buffer_load_dword v10, s[24:27], s52 offen lds
L_we_e:
    s_setprio 0
    s_branch L_attn
L_l_postattn:
    s_setprio 1
    s_barrier
    s_cmp_lg_u32 s40, 0
    s_cbranch_scc1 L_sig3_skip
    s_cmp_lg_u32 s38, 4
    s_cbranch_scc1 L_sig3_skip
    s_add_u32 s74, s87, 3
    s_lshl_b32 s51, s37, 5
    s_add_u32 s51, s51, s36
    s_lshl_b32 s51, s51, 7
    s_add_u32 s51, s51, 29360128
    v_mov_b32 v20, s74
    v_mov_b32 v22, s51
    s_mov_b64 exec, 1
    buffer_store_dword v20, v22, s[24:27], 0 offen sc1
    s_mov_b64 exec, -1
L_sig3_skip:
    s_add_u32 m0, s48, 0
    s_add_u32 s49, s56, 0
    buffer_load_dwordx4 v1, s[24:27], s49 offen sc1 lds
    s_add_u32 m0, s48, 4096
    s_add_u32 s49, s56, 4096
    buffer_load_dwordx4 v1, s[24:27], s49 offen sc1 lds
    s_add_u32 m0, s48, 8192
    s_add_u32 s49, s56, 8192
    buffer_load_dwordx4 v1, s[24:27], s49 offen sc1 lds
    s_add_u32 m0, s48, 12288
    s_add_u32 s49, s56, 12288
    buffer_load_dwordx4 v1, s[24:27], s49 offen sc1 lds
    s_add_u32 m0, s48, 16384
    s_add_u32 s49, s56, 16384
    buffer_load_dwordx4 v1, s[24:27], s49 offen sc1 lds
    s_add_u32 m0, s48, 20480
    s_add_u32 s49, s56, 20480
    buffer_load_dwordx4 v1, s[24:27], s49 offen sc1 lds
    s_add_u32 m0, s48, 24576
    s_add_u32 s49, s56, 24576
    buffer_load_dwordx4 v1, s[24:27], s49 offen sc1 lds
    s_add_u32 m0, s48, 28672
    s_add_u32 s49, s56, 28672
    buffer_load_dwordx4 v1, s[24:27], s49 offen sc1 lds
    s_add_u32 m0, s48, 32768
    s_add_u32 s49, s56, 32768
    buffer_load_dwordx4 v1, s[24:27], s49 offen sc1 lds
    s_add_u32 m0, s48, 36864
    s_add_u32 s49, s56, 36864
    buffer_load_dwordx4 v1, s[24:27], s49 offen sc1 lds
    s_barrier
    s_barrier
    s_add_u32 m0, s48, 40960
    s_add_u32 s49, s56, 40960
    buffer_load_dwordx4 v1, s[24:27], s49 offen sc1 lds
    s_add_u32 m0, s48, 45056
    s_add_u32 s49, s56, 45056
    buffer_load_dwordx4 v1, s[24:27], s49 offen sc1 lds
    s_add_u32 m0, s48, 49152
    s_add_u32 s49, s56, 49152
    buffer_load_dwordx4 v1, s[24:27], s49 offen sc1 lds
    s_add_u32 m0, s48, 53248
    s_add_u32 s49, s56, 53248
    buffer_load_dwordx4 v1, s[24:27], s49 offen sc1 lds
    s_add_u32 m0, s48, 57344
    s_add_u32 s49, s56, 57344
    buffer_load_dwordx4 v1, s[24:27], s49 offen sc1 lds
    s_add_u32 m0, s48, 61440
    s_add_u32 s49, s56, 61440
    buffer_load_dwordx4 v1, s[24:27], s49 offen sc1 lds
    s_barrier
    s_barrier
    s_add_u32 m0, s48, 65536
    s_add_u32 s49, s56, 65536
    buffer_load_dwordx4 v1, s[24:27], s49 offen sc1 lds
    s_add_u32 m0, s48, 69632
    s_add_u32 s49, s56, 69632
    buffer_load_dwordx4 v1, s[24:27], s49 offen sc1 lds
    s_add_u32 m0, s48, 73728
    s_add_u32 s49, s56, 73728
    buffer_load_dwordx4 v1, s[24:27], s49 offen sc1 lds
    s_add_u32 m0, s48, 77824
    s_add_u32 s49, s56, 77824
    buffer_load_dwordx4 v1, s[24:27], s49 offen sc1 lds
    s_add_u32 m0, s48, 81920
    s_add_u32 s49, s56, 81920
    buffer_load_dwordx4 v1, s[24:27], s49 offen sc1 lds
    s_add_u32 m0, s48, 86016
    s_add_u32 s49, s56, 86016
    buffer_load_dwordx4 v1, s[24:27], s49 offen sc1 lds
    s_barrier
    s_cmp_lg_u32 s40, 0
    s_cbranch_scc1 L_l_p4b
    v_bfe_u32 v89, v0, 4, 1
    v_and_b32 v90, 15, v0
    v_cmp_eq_u32 s[70:71], v89, v90
    v_mov_b32 v91, 0x3f803f80
    v_mov_b32 v92, 0
    s_nop 0
    v_cndmask_b32 v84, v92, v91, s[70:71]
    v_cndmask_b32 v85, v92, v91, s[70:71]
    v_cndmask_b32 v86, v92, v91, s[70:71]
    v_cndmask_b32 v87, v92, v91, s[70:71]
    s_lshl_b32 s50, s39, 7
    s_add_u32 s50, s50, 162048
    v_lshlrev_b32 v88, 2, v0
    v_add_u32 v88, s50, v88
    s_add_u32 m0, s48, 90112
    s_add_u32 s49, s53, 0
    buffer_load_dwordx4 v1, s[24:27], s49 offen sc1 lds
    s_add_u32 m0, s48, 94208
    s_add_u32 s49, s53, 2048
    buffer_load_dwordx4 v1, s[24:27], s49 offen sc1 lds
    s_add_u32 m0, s48, 98304
    s_add_u32 s49, s53, 4096
    buffer_load_dwordx4 v1, s[24:27], s49 offen sc1 lds
    s_add_u32 m0, s48, 102400
    s_add_u32 s49, s53, 6144
    buffer_load_dwordx4 v1, s[24:27], s49 offen sc1 lds
    s_add_u32 m0, s48, 106496
    s_add_u32 s49, s53, 8192
    buffer_load_dwordx4 v1, s[24:27], s49 offen sc1 lds
    s_add_u32 m0, s48, 110592
    s_add_u32 s49, s53, 10240
    buffer_load_dwordx4 v1, s[24:27], s49 offen sc1 lds
    s_add_u32 m0, s48, 114688
    s_add_u32 s49, s53, 12288
    buffer_load_dwordx4 v1, s[24:27], s49 offen sc1 lds
    s_add_u32 m0, s48, 118784
    s_add_u32 s49, s53, 14336
    buffer_load_dwordx4 v1, s[24:27], s49 offen sc1 lds
    s_add_u32 m0, s48, 122880
    s_add_u32 s49, s53, 16384
    buffer_load_dwordx4 v1, s[24:27], s49 offen sc1 lds
    s_add_u32 m0, s48, 126976
    s_add_u32 s49, s53, 18432
    buffer_load_dwordx4 v1, s[24:27], s49 offen sc1 lds
    s_add_u32 m0, s48, 131072
    s_add_u32 s49, s53, 20480
    buffer_load_dwordx4 v1, s[24:27], s49 offen sc1 lds
    s_add_u32 m0, s48, 135168
    s_add_u32 s49, s53, 22528
    buffer_load_dwordx4 v1, s[24:27], s49 offen sc1 lds
    s_waitcnt vmcnt(10)
    s_barrier
    s_cmp_ge_u32 s39, 2
    s_cbranch_scc1 L_p4_cs0_1388
    ds_read_b128 v[64:67], v11 offset:0
    ds_read_b128 v[68:71], v11 offset:2048
    ds_read_b128 v[72:75], v11 offset:4096
    ds_read_b128 v[76:79], v11 offset:6144
L_p4_cs0_1388:
    s_add_u32 m0, s48, 139264
    s_add_u32 s49, s53, 24576
    buffer_load_dwordx4 v1, s[24:27], s49 offen sc1 lds
    s_add_u32 m0, s48, 143360
    s_add_u32 s49, s53, 26624
    buffer_load_dwordx4 v1, s[24:27], s49 offen sc1 lds
    s_waitcnt vmcnt(10)
    s_barrier
    s_cmp_ge_u32 s39, 2
    s_cbranch_scc1 L_p4_cs1_1403
    s_waitcnt lgkmcnt(0)
    v_mfma_f32_16x16x32_bf16 v[80:83], v[84:87], v[64:67], 0
    v_mfma_f32_16x16x32_bf16 v[80:83], v[84:87], v[68:71], v[80:83]
    v_mfma_f32_16x16x32_bf16 v[80:83], v[84:87], v[72:75], v[80:83]
    v_mfma_f32_16x16x32_bf16 v[80:83], v[84:87], v[76:79], v[80:83]
    ds_read_b128 v[64:67], v11 offset:8192
    ds_read_b128 v[68:71], v11 offset:10240
    ds_read_b128 v[72:75], v11 offset:12288
    ds_read_b128 v[76:79], v11 offset:14336
L_p4_cs1_1403:
    s_add_u32 m0, s48, 147456
    s_add_u32 s49, s53, 28672
    buffer_load_dwordx4 v1, s[24:27], s49 offen sc1 lds
    s_add_u32 m0, s48, 151552
    s_add_u32 s49, s53, 30720
    buffer_load_dwordx4 v1, s[24:27], s49 offen sc1 lds
    s_waitcnt vmcnt(10)
    s_barrier
    s_cmp_ge_u32 s39, 2
    s_cbranch_scc1 L_p4_cs2_1423
    s_waitcnt lgkmcnt(0)
    v_mfma_f32_16x16x32_bf16 v[80:83], v[84:87], v[64:67], v[80:83]
    v_mfma_f32_16x16x32_bf16 v[80:83], v[84:87], v[68:71], v[80:83]
    v_mfma_f32_16x16x32_bf16 v[80:83], v[84:87], v[72:75], v[80:83]
    v_mfma_f32_16x16x32_bf16 v[80:83], v[84:87], v[76:79], v[80:83]
    ds_read_b128 v[64:67], v11 offset:16384
    ds_read_b128 v[68:71], v11 offset:18432
    ds_read_b128 v[72:75], v11 offset:20480
    ds_read_b128 v[76:79], v11 offset:22528
L_p4_cs2_1423:
    s_lshl_b32 s50, s42, 12
    s_add_u32 s50, s50, s59
    buffer_load_dwordx4 v[32:35], v1, s[24:27], s50 offen offset:0 sc1
    buffer_load_dwordx4 v[36:39], v1, s[24:27], s50 offen offset:1024 sc1
    buffer_load_dwordx4 v[40:43], v1, s[24:27], s50 offen offset:2048 sc1
    buffer_load_dwordx4 v[44:47], v1, s[24:27], s50 offen offset:3072 sc1
    s_waitcnt vmcnt(12)
    s_barrier
    s_cmp_ge_u32 s39, 2
    s_cbranch_scc1 L_p4_cs3_1443
    s_waitcnt lgkmcnt(0)
    v_mfma_f32_16x16x32_bf16 v[80:83], v[84:87], v[64:67], v[80:83]
    v_mfma_f32_16x16x32_bf16 v[80:83], v[84:87], v[68:71], v[80:83]
    v_mfma_f32_16x16x32_bf16 v[80:83], v[84:87], v[72:75], v[80:83]
    v_mfma_f32_16x16x32_bf16 v[80:83], v[84:87], v[76:79], v[80:83]
    ds_read_b128 v[64:67], v11 offset:24576
    ds_read_b128 v[68:71], v11 offset:26624
    ds_read_b128 v[72:75], v11 offset:28672
    ds_read_b128 v[76:79], v11 offset:30720
L_p4_cs3_1443:
    s_add_u32 m0, s48, 0
    s_add_u32 s49, s56, 90112
    buffer_load_dwordx4 v1, s[24:27], s49 offen sc1 lds
    s_add_u32 m0, s48, 4096
    s_add_u32 s49, s56, 94208
    buffer_load_dwordx4 v1, s[24:27], s49 offen sc1 lds
    s_waitcnt vmcnt(12)
    s_barrier
    s_cmp_ge_u32 s39, 2
    s_cbranch_scc1 L_p4_cs4_1463
    s_waitcnt lgkmcnt(0)
    v_mfma_f32_16x16x32_bf16 v[80:83], v[84:87], v[64:67], v[80:83]
    v_mfma_f32_16x16x32_bf16 v[80:83], v[84:87], v[68:71], v[80:83]
    v_mfma_f32_16x16x32_bf16 v[80:83], v[84:87], v[72:75], v[80:83]
    v_mfma_f32_16x16x32_bf16 v[80:83], v[84:87], v[76:79], v[80:83]
    ds_read_b128 v[64:67], v11 offset:32768
    ds_read_b128 v[68:71], v11 offset:34816
    ds_read_b128 v[72:75], v11 offset:36864
    ds_read_b128 v[76:79], v11 offset:38912
L_p4_cs4_1463:
    s_add_u32 m0, s48, 8192
    s_add_u32 s49, s56, 98304
    buffer_load_dwordx4 v1, s[24:27], s49 offen sc1 lds
    s_add_u32 m0, s48, 12288
    s_add_u32 s49, s56, 102400
    buffer_load_dwordx4 v1, s[24:27], s49 offen sc1 lds
    s_waitcnt vmcnt(12)
    s_barrier
    s_cmp_ge_u32 s39, 2
    s_cbranch_scc1 L_p4_cs5_1483
    s_waitcnt lgkmcnt(0)
    v_mfma_f32_16x16x32_bf16 v[80:83], v[84:87], v[64:67], v[80:83]
    v_mfma_f32_16x16x32_bf16 v[80:83], v[84:87], v[68:71], v[80:83]
    v_mfma_f32_16x16x32_bf16 v[80:83], v[84:87], v[72:75], v[80:83]
    v_mfma_f32_16x16x32_bf16 v[80:83], v[84:87], v[76:79], v[80:83]
    ds_read_b128 v[64:67], v11 offset:40960
    ds_read_b128 v[68:71], v11 offset:43008
    ds_read_b128 v[72:75], v11 offset:45056
    ds_read_b128 v[76:79], v11 offset:47104
L_p4_cs5_1483:
    s_add_u32 m0, s48, 16384
    s_add_u32 s49, s56, 106496
    buffer_load_dwordx4 v1, s[24:27], s49 offen sc1 lds
    s_add_u32 m0, s48, 20480
    s_add_u32 s49, s56, 110592
    buffer_load_dwordx4 v1, s[24:27], s49 offen sc1 lds
    s_waitcnt vmcnt(12)
    s_barrier
    s_cmp_ge_u32 s39, 2
    s_cbranch_scc1 L_p4_cs6_1503
    s_waitcnt lgkmcnt(0)
    v_mfma_f32_16x16x32_bf16 v[80:83], v[84:87], v[64:67], v[80:83]
    v_mfma_f32_16x16x32_bf16 v[80:83], v[84:87], v[68:71], v[80:83]
    v_mfma_f32_16x16x32_bf16 v[80:83], v[84:87], v[72:75], v[80:83]
    v_mfma_f32_16x16x32_bf16 v[80:83], v[84:87], v[76:79], v[80:83]
    ds_read_b128 v[64:67], v11 offset:49152
    ds_read_b128 v[68:71], v11 offset:51200
    ds_read_b128 v[72:75], v11 offset:53248
    ds_read_b128 v[76:79], v11 offset:55296
L_p4_cs6_1503:
    s_add_u32 m0, s48, 24576
    s_add_u32 s49, s56, 114688
    buffer_load_dwordx4 v1, s[24:27], s49 offen sc1 lds
    s_add_u32 m0, s48, 28672
    s_add_u32 s49, s56, 118784
    buffer_load_dwordx4 v1, s[24:27], s49 offen sc1 lds
    s_waitcnt vmcnt(8)
    v_add_f32 v32, v32, v40
    v_add_f32 v33, v33, v41
    v_add_f32 v34, v34, v42
    v_add_f32 v35, v35, v43
    v_add_f32 v36, v36, v44
    v_add_f32 v37, v37, v45
    v_add_f32 v38, v38, v46
    v_add_f32 v39, v39, v47
    v_add_f32 v32, v32, v36
    v_add_f32 v33, v33, v37
    v_add_f32 v34, v34, v38
    v_add_f32 v35, v35, v39
    v_add_f32 v32, v32, v34
    v_add_f32 v33, v33, v35
    v_add_f32 v32, v32, v33
    s_barrier
    s_cmp_ge_u32 s39, 2
    s_cbranch_scc1 L_p4_cs7_1538
    s_waitcnt lgkmcnt(0)
    v_mfma_f32_16x16x32_bf16 v[80:83], v[84:87], v[64:67], v[80:83]
    v_mfma_f32_16x16x32_bf16 v[80:83], v[84:87], v[68:71], v[80:83]
    v_mfma_f32_16x16x32_bf16 v[80:83], v[84:87], v[72:75], v[80:83]
    v_mfma_f32_16x16x32_bf16 v[80:83], v[84:87], v[76:79], v[80:83]
    ds_read_b128 v[64:67], v11 offset:57344
    ds_read_b128 v[68:71], v11 offset:59392
    ds_read_b128 v[72:75], v11 offset:61440
    ds_read_b128 v[76:79], v11 offset:63488
L_p4_cs7_1538:
    s_add_u32 m0, s48, 32768
    s_add_u32 s49, s56, 122880
    buffer_load_dwordx4 v1, s[24:27], s49 offen sc1 lds
    s_add_u32 m0, s48, 36864
    s_add_u32 s49, s56, 126976
    buffer_load_dwordx4 v1, s[24:27], s49 offen sc1 lds
    v_mov_b32 v48, v32
    v_cmp_gt_u32 s[70:71], 32, v0
    s_nop 0
    v_permlane32_swap_b32 v32, v48
    v_mul_f32 v32, s82, v32
    v_mul_f32 v48, s82, v48
    v_fma_f32 v48, -v32, v32, v48
    v_max_f32 v48, 0, v48
    v_add_f32 v49, s83, v48
    v_rsq_f32 v49, v49
    s_nop 0
    v_mul_f32 v50, v49, v49
    v_mul_f32 v50, v50, v48
    v_add_f32 v50, s83, v50
    v_rsq_f32 v50, v50
    s_nop 0
    v_mul_f32 v49, v49, v50
    v_cndmask_b32 v51, v49, v32, s[70:71]
    ds_write_b32 v9, v51
    s_barrier
    v_and_b32 v26, 31, v0
    s_lshl_b32 s51, s37, 5
    v_add_u32 v26, s51, v26
    v_lshlrev_b32 v26, 7, v26
    v_add_u32 v26, 29360128, v26
    buffer_load_dword v27, v26, s[24:27], 0 offen sc1
    s_cmp_ge_u32 s39, 2
    s_cbranch_scc1 L_p4_cs8_1582
    s_waitcnt lgkmcnt(0)
    v_mfma_f32_16x16x32_bf16 v[80:83], v[84:87], v[64:67], v[80:83]
    v_mfma_f32_16x16x32_bf16 v[80:83], v[84:87], v[68:71], v[80:83]
    v_mfma_f32_16x16x32_bf16 v[80:83], v[84:87], v[72:75], v[80:83]
    v_mfma_f32_16x16x32_bf16 v[80:83], v[84:87], v[76:79], v[80:83]
    s_nop 7
    s_mov_b64 exec, s[78:79]
    ds_write_b32 v88, v80 offset:0
    ds_write_b32 v88, v81 offset:64
    s_mov_b64 exec, -1
    ds_read_b128 v[64:67], v12 offset:0
    ds_read_b128 v[68:71], v12 offset:2048
    ds_read_b128 v[72:75], v12 offset:4096
    ds_read_b128 v[76:79], v12 offset:6144
L_p4_cs8_1582:
    s_add_u32 m0, s48, 90112
    s_add_u32 s49, s56, 131072
    buffer_load_dwordx4 v1, s[24:27], s49 offen sc1 lds
    s_add_u32 m0, s48, 94208
    s_add_u32 s49, s56, 135168
    buffer_load_dwordx4 v1, s[24:27], s49 offen sc1 lds
    s_waitcnt lgkmcnt(0)
    s_barrier
    s_cmp_ge_u32 s39, 2
    s_cbranch_scc1 L_p4_cs9_1607
    s_waitcnt lgkmcnt(0)
    v_mfma_f32_16x16x32_bf16 v[80:83], v[84:87], v[64:67], 0
    v_mfma_f32_16x16x32_bf16 v[80:83], v[84:87], v[68:71], v[80:83]
    v_mfma_f32_16x16x32_bf16 v[80:83], v[84:87], v[72:75], v[80:83]
    v_mfma_f32_16x16x32_bf16 v[80:83], v[84:87], v[76:79], v[80:83]
    ds_read_b128 v[64:67], v12 offset:8192
    ds_read_b128 v[68:71], v12 offset:10240
    ds_read_b128 v[72:75], v12 offset:12288
    ds_read_b128 v[76:79], v12 offset:14336
L_p4_cs9_1607:
    s_add_u32 m0, s48, 98304
    s_add_u32 s49, s56, 139264
    buffer_load_dwordx4 v1, s[24:27], s49 offen sc1 lds
    s_add_u32 m0, s48, 102400
    s_add_u32 s49, s56, 143360
    buffer_load_dwordx4 v1, s[24:27], s49 offen sc1 lds
    s_barrier
    s_cmp_ge_u32 s39, 2
    s_cbranch_scc1 L_p4_cs10_1626
    s_waitcnt lgkmcnt(0)
    v_mfma_f32_16x16x32_bf16 v[80:83], v[84:87], v[64:67], v[80:83]
    v_mfma_f32_16x16x32_bf16 v[80:83], v[84:87], v[68:71], v[80:83]
    v_mfma_f32_16x16x32_bf16 v[80:83], v[84:87], v[72:75], v[80:83]
    v_mfma_f32_16x16x32_bf16 v[80:83], v[84:87], v[76:79], v[80:83]
    ds_read_b128 v[64:67], v12 offset:16384
    ds_read_b128 v[68:71], v12 offset:18432
    ds_read_b128 v[72:75], v12 offset:20480
    ds_read_b128 v[76:79], v12 offset:22528
L_p4_cs10_1626:
    s_add_u32 m0, s48, 106496
    s_add_u32 s49, s56, 147456
    buffer_load_dwordx4 v1, s[24:27], s49 offen sc1 lds
    s_add_u32 m0, s48, 110592
    s_add_u32 s49, s56, 151552
    buffer_load_dwordx4 v1, s[24:27], s49 offen sc1 lds
    s_waitcnt vmcnt(15)
    s_barrier
    s_cmp_ge_u32 s39, 2
    s_cbranch_scc1 L_p4_cs11_1646
    s_waitcnt lgkmcnt(0)
    v_mfma_f32_16x16x32_bf16 v[80:83], v[84:87], v[64:67], v[80:83]
    v_mfma_f32_16x16x32_bf16 v[80:83], v[84:87], v[68:71], v[80:83]
    v_mfma_f32_16x16x32_bf16 v[80:83], v[84:87], v[72:75], v[80:83]
    v_mfma_f32_16x16x32_bf16 v[80:83], v[84:87], v[76:79], v[80:83]
    ds_read_b128 v[64:67], v11 offset:0
    ds_read_b128 v[68:71], v11 offset:2048
    ds_read_b128 v[72:75], v11 offset:4096
    ds_read_b128 v[76:79], v11 offset:6144
L_p4_cs11_1646:
    s_add_u32 m0, s48, 114688
    s_add_u32 s49, s56, 155648
    buffer_load_dwordx4 v1, s[24:27], s49 offen sc1 lds
    s_add_u32 m0, s48, 118784
    s_add_u32 s49, s56, 159744
    buffer_load_dwordx4 v1, s[24:27], s49 offen sc1 lds
    s_waitcnt vmcnt(15)
    s_barrier
    s_cmp_ge_u32 s39, 2
    s_cbranch_scc1 L_p4_cs12_1666
    s_waitcnt lgkmcnt(0)
    v_mfma_f32_16x16x32_bf16 v[80:83], v[84:87], v[64:67], v[80:83]
    v_mfma_f32_16x16x32_bf16 v[80:83], v[84:87], v[68:71], v[80:83]
    v_mfma_f32_16x16x32_bf16 v[80:83], v[84:87], v[72:75], v[80:83]
    v_mfma_f32_16x16x32_bf16 v[80:83], v[84:87], v[76:79], v[80:83]
    ds_read_b128 v[64:67], v11 offset:8192
    ds_read_b128 v[68:71], v11 offset:10240
    ds_read_b128 v[72:75], v11 offset:12288
    ds_read_b128 v[76:79], v11 offset:14336
L_p4_cs12_1666:
    s_add_u32 m0, s48, 122880
    s_add_u32 s49, s56, 163840
    buffer_load_dwordx4 v1, s[24:27], s49 offen sc1 lds
    s_add_u32 m0, s48, 126976
    s_add_u32 s49, s56, 167936
    buffer_load_dwordx4 v1, s[24:27], s49 offen sc1 lds
    s_waitcnt vmcnt(15)
    s_barrier
    s_cmp_ge_u32 s39, 2
    s_cbranch_scc1 L_p4_cs13_1686
    s_waitcnt lgkmcnt(0)
    v_mfma_f32_16x16x32_bf16 v[80:83], v[84:87], v[64:67], v[80:83]
    v_mfma_f32_16x16x32_bf16 v[80:83], v[84:87], v[68:71], v[80:83]
    v_mfma_f32_16x16x32_bf16 v[80:83], v[84:87], v[72:75], v[80:83]
    v_mfma_f32_16x16x32_bf16 v[80:83], v[84:87], v[76:79], v[80:83]
    ds_read_b128 v[64:67], v11 offset:16384
    ds_read_b128 v[68:71], v11 offset:18432
    ds_read_b128 v[72:75], v11 offset:20480
    ds_read_b128 v[76:79], v11 offset:22528
L_p4_cs13_1686:
    s_add_u32 m0, s48, 131072
    s_add_u32 s49, s56, 172032
    buffer_load_dwordx4 v1, s[24:27], s49 offen sc1 lds
    s_add_u32 m0, s48, 135168
    s_add_u32 s49, s56, 176128
    buffer_load_dwordx4 v1, s[24:27], s49 offen sc1 lds
    s_waitcnt vmcnt(15)
    s_barrier
    s_waitcnt vmcnt(12)
    s_add_u32 s74, s87, 3
    v_subrev_u32 v27, s74, v27
    v_cmp_le_u32 vcc, 8, v27
    s_nop 1
    s_cbranch_vccz L_s3_ok
    s_mov_b32 s60, 400000
L_s3p:
    buffer_load_dword v27, v26, s[24:27], 0 offen sc1
    s_waitcnt vmcnt(0)
    v_subrev_u32 v27, s74, v27
    v_cmp_le_u32 vcc, 8, v27
    s_sub_u32 s60, s60, 1
    s_cbranch_scc1 L_s3p_x
    s_cbranch_vccnz L_s3p
L_s3p_x:
L_s3_ok:
    s_cmp_ge_u32 s39, 2
    s_cbranch_scc1 L_p4_cs14_1723
    s_waitcnt lgkmcnt(0)
    v_mfma_f32_16x16x32_bf16 v[80:83], v[84:87], v[64:67], v[80:83]
    v_mfma_f32_16x16x32_bf16 v[80:83], v[84:87], v[68:71], v[80:83]
    v_mfma_f32_16x16x32_bf16 v[80:83], v[84:87], v[72:75], v[80:83]
    v_mfma_f32_16x16x32_bf16 v[80:83], v[84:87], v[76:79], v[80:83]
    ds_read_b128 v[64:67], v11 offset:24576
    ds_read_b128 v[68:71], v11 offset:26624
    ds_read_b128 v[72:75], v11 offset:28672
    ds_read_b128 v[76:79], v11 offset:30720
L_p4_cs14_1723:
    s_add_u32 m0, s48, 139264
    s_add_u32 s49, s56, 180224
    buffer_load_dwordx4 v1, s[24:27], s49 offen sc1 lds
    s_add_u32 m0, s48, 143360
    s_add_u32 s49, s56, 184320
    buffer_load_dwordx4 v1, s[24:27], s49 offen sc1 lds
    s_barrier
    s_cmp_ge_u32 s39, 2
    s_cbranch_scc1 L_p4_cs15_1742
    s_waitcnt lgkmcnt(0)
    v_mfma_f32_16x16x32_bf16 v[80:83], v[84:87], v[64:67], v[80:83]
    v_mfma_f32_16x16x32_bf16 v[80:83], v[84:87], v[68:71], v[80:83]
    v_mfma_f32_16x16x32_bf16 v[80:83], v[84:87], v[72:75], v[80:83]
    v_mfma_f32_16x16x32_bf16 v[80:83], v[84:87], v[76:79], v[80:83]
    ds_read_b128 v[64:67], v11 offset:32768
    ds_read_b128 v[68:71], v11 offset:34816
    ds_read_b128 v[72:75], v11 offset:36864
    ds_read_b128 v[76:79], v11 offset:38912
L_p4_cs15_1742:
    s_add_u32 m0, s48, 147456
    s_add_u32 s49, s56, 188416
    buffer_load_dwordx4 v1, s[24:27], s49 offen sc1 lds
    s_add_u32 m0, s48, 151552
    s_add_u32 s49, s56, 192512
    buffer_load_dwordx4 v1, s[24:27], s49 offen sc1 lds
    s_waitcnt vmcnt(14)
    s_barrier
    s_cmp_ge_u32 s39, 2
    s_cbranch_scc1 L_p4_cs16_1762
    s_waitcnt lgkmcnt(0)
    v_mfma_f32_16x16x32_bf16 v[80:83], v[84:87], v[64:67], v[80:83]
    v_mfma_f32_16x16x32_bf16 v[80:83], v[84:87], v[68:71], v[80:83]
    v_mfma_f32_16x16x32_bf16 v[80:83], v[84:87], v[72:75], v[80:83]
    v_mfma_f32_16x16x32_bf16 v[80:83], v[84:87], v[76:79], v[80:83]
    s_nop 7
    s_mov_b64 exec, s[78:79]
    ds_write_b32 v88, v80 offset:256
    ds_write_b32 v88, v81 offset:320
    s_mov_b64 exec, -1
    ds_read_b128 v[64:67], v12 offset:24576
    ds_read_b128 v[68:71], v12 offset:26624
    ds_read_b128 v[72:75], v12 offset:28672
    ds_read_b128 v[76:79], v12 offset:30720
L_p4_cs16_1762:
    s_add_u32 m0, s48, 40960
    s_add_u32 s49, s100, 0
    buffer_load_dwordx4 v1, s[24:27], s49 offen sc1 lds
    s_add_u32 m0, s48, 45056
    s_add_u32 s49, s100, 4096
    buffer_load_dwordx4 v1, s[24:27], s49 offen sc1 lds
    s_waitcnt vmcnt(14)
    s_waitcnt lgkmcnt(0)
    s_barrier
    s_cmp_ge_u32 s39, 2
    s_cbranch_scc1 L_p4_cs17_1788
    s_waitcnt lgkmcnt(0)
    v_mfma_f32_16x16x32_bf16 v[80:83], v[84:87], v[64:67], 0
    v_mfma_f32_16x16x32_bf16 v[80:83], v[84:87], v[68:71], v[80:83]
    v_mfma_f32_16x16x32_bf16 v[80:83], v[84:87], v[72:75], v[80:83]
    v_mfma_f32_16x16x32_bf16 v[80:83], v[84:87], v[76:79], v[80:83]
    ds_read_b128 v[64:67], v12 offset:32768
    ds_read_b128 v[68:71], v12 offset:34816
    ds_read_b128 v[72:75], v12 offset:36864
    ds_read_b128 v[76:79], v12 offset:38912
L_p4_cs17_1788:
    s_add_u32 m0, s48, 49152
    s_add_u32 s49, s100, 8192
    buffer_load_dwordx4 v1, s[24:27], s49 offen sc1 lds
    s_add_u32 m0, s48, 53248
    s_add_u32 s49, s100, 12288
    buffer_load_dwordx4 v1, s[24:27], s49 offen sc1 lds
    s_waitcnt vmcnt(14)
    s_barrier
    s_cmp_ge_u32 s39, 2
    s_cbranch_scc1 L_p4_cs18_1808
    s_waitcnt lgkmcnt(0)
    v_mfma_f32_16x16x32_bf16 v[80:83], v[84:87], v[64:67], v[80:83]
    v_mfma_f32_16x16x32_bf16 v[80:83], v[84:87], v[68:71], v[80:83]
    v_mfma_f32_16x16x32_bf16 v[80:83], v[84:87], v[72:75], v[80:83]
    v_mfma_f32_16x16x32_bf16 v[80:83], v[84:87], v[76:79], v[80:83]
    ds_read_b128 v[64:67], v12 offset:40960
    ds_read_b128 v[68:71], v12 offset:43008
    ds_read_b128 v[72:75], v12 offset:45056
    ds_read_b128 v[76:79], v12 offset:47104
L_p4_cs18_1808:
    s_add_u32 m0, s48, 57344
    s_add_u32 s49, s100, 16384
    buffer_load_dwordx4 v1, s[24:27], s49 offen sc1 lds
    s_add_u32 m0, s48, 61440
    s_add_u32 s49, s100, 20480
    buffer_load_dwordx4 v1, s[24:27], s49 offen sc1 lds
    s_waitcnt vmcnt(14)
    s_barrier
    s_cmp_ge_u32 s39, 2
    s_cbranch_scc1 L_p4_cs19_1828
    s_waitcnt lgkmcnt(0)
    v_mfma_f32_16x16x32_bf16 v[80:83], v[84:87], v[64:67], v[80:83]
    v_mfma_f32_16x16x32_bf16 v[80:83], v[84:87], v[68:71], v[80:83]
    v_mfma_f32_16x16x32_bf16 v[80:83], v[84:87], v[72:75], v[80:83]
    v_mfma_f32_16x16x32_bf16 v[80:83], v[84:87], v[76:79], v[80:83]
    ds_read_b128 v[64:67], v12 offset:49152
    ds_read_b128 v[68:71], v12 offset:51200
    ds_read_b128 v[72:75], v12 offset:53248
    ds_read_b128 v[76:79], v12 offset:55296
L_p4_cs19_1828:
    s_add_u32 m0, s48, 65536
    s_add_u32 s49, s100, 24576
    buffer_load_dwordx4 v1, s[24:27], s49 offen sc1 lds
    s_add_u32 m0, s48, 69632
    s_add_u32 s49, s100, 28672
    buffer_load_dwordx4 v1, s[24:27], s49 offen sc1 lds
    s_waitcnt vmcnt(14)
    s_barrier
    s_cmp_ge_u32 s39, 2
    s_cbranch_scc1 L_p4_cs20_1848
    s_waitcnt lgkmcnt(0)
    v_mfma_f32_16x16x32_bf16 v[80:83], v[84:87], v[64:67], v[80:83]
    v_mfma_f32_16x16x32_bf16 v[80:83], v[84:87], v[68:71], v[80:83]
    v_mfma_f32_16x16x32_bf16 v[80:83], v[84:87], v[72:75], v[80:83]
    v_mfma_f32_16x16x32_bf16 v[80:83], v[84:87], v[76:79], v[80:83]
    ds_read_b128 v[64:67], v12 offset:57344
    ds_read_b128 v[68:71], v12 offset:59392
    ds_read_b128 v[72:75], v12 offset:61440
    ds_read_b128 v[76:79], v12 offset:63488
L_p4_cs20_1848:
    s_add_u32 m0, s48, 73728
    s_add_u32 s49, s100, 32768
    buffer_load_dwordx4 v1, s[24:27], s49 offen sc1 lds
    s_add_u32 m0, s48, 77824
    s_add_u32 s49, s100, 36864
    buffer_load_dwordx4 v1, s[24:27], s49 offen sc1 lds
    s_waitcnt vmcnt(14)
    s_barrier
    s_cmp_ge_u32 s39, 2
    s_cbranch_scc1 L_p4_cs21_1868
    s_waitcnt lgkmcnt(0)
    v_mfma_f32_16x16x32_bf16 v[80:83], v[84:87], v[64:67], v[80:83]
    v_mfma_f32_16x16x32_bf16 v[80:83], v[84:87], v[68:71], v[80:83]
    v_mfma_f32_16x16x32_bf16 v[80:83], v[84:87], v[72:75], v[80:83]
    v_mfma_f32_16x16x32_bf16 v[80:83], v[84:87], v[76:79], v[80:83]
    ds_read_b128 v[64:67], v13 offset:0
    ds_read_b128 v[68:71], v13 offset:2048
    ds_read_b128 v[72:75], v13 offset:4096
    ds_read_b128 v[76:79], v13 offset:6144
L_p4_cs21_1868:
    s_add_u32 m0, s48, 81920
    s_add_u32 s49, s100, 40960
    buffer_load_dwordx4 v1, s[24:27], s49 offen sc1 lds
    s_add_u32 m0, s48, 86016
    s_add_u32 s49, s100, 45056
    buffer_load_dwordx4 v1, s[24:27], s49 offen sc1 lds
    s_waitcnt vmcnt(14)
    s_barrier
    s_cmp_ge_u32 s39, 2
    s_cbranch_scc1 L_p4_cs22_1888
    s_waitcnt lgkmcnt(0)
    v_mfma_f32_16x16x32_bf16 v[80:83], v[84:87], v[64:67], v[80:83]
    v_mfma_f32_16x16x32_bf16 v[80:83], v[84:87], v[68:71], v[80:83]
    v_mfma_f32_16x16x32_bf16 v[80:83], v[84:87], v[72:75], v[80:83]
    v_mfma_f32_16x16x32_bf16 v[80:83], v[84:87], v[76:79], v[80:83]
    ds_read_b128 v[64:67], v13 offset:8192
    ds_read_b128 v[68:71], v13 offset:10240
    ds_read_b128 v[72:75], v13 offset:12288
    ds_read_b128 v[76:79], v13 offset:14336
L_p4_cs22_1888:
    s_add_u32 m0, s48, 0
    s_add_u32 s49, s100, 49152
    buffer_load_dwordx4 v1, s[24:27], s49 offen sc1 lds
    s_add_u32 m0, s48, 4096
    s_add_u32 s49, s100, 53248
    buffer_load_dwordx4 v1, s[24:27], s49 offen sc1 lds
    s_waitcnt vmcnt(14)
    s_barrier
    s_cmp_ge_u32 s39, 2
    s_cbranch_scc1 L_p4_cs23_1908
    s_waitcnt lgkmcnt(0)
    v_mfma_f32_16x16x32_bf16 v[80:83], v[84:87], v[64:67], v[80:83]
    v_mfma_f32_16x16x32_bf16 v[80:83], v[84:87], v[68:71], v[80:83]
    v_mfma_f32_16x16x32_bf16 v[80:83], v[84:87], v[72:75], v[80:83]
    v_mfma_f32_16x16x32_bf16 v[80:83], v[84:87], v[76:79], v[80:83]
    ds_read_b128 v[64:67], v13 offset:16384
    ds_read_b128 v[68:71], v13 offset:18432
    ds_read_b128 v[72:75], v13 offset:20480
    ds_read_b128 v[76:79], v13 offset:22528
    s_waitcnt lgkmcnt(0)
    v_mfma_f32_16x16x32_bf16 v[80:83], v[84:87], v[64:67], v[80:83]
    v_mfma_f32_16x16x32_bf16 v[80:83], v[84:87], v[68:71], v[80:83]
    v_mfma_f32_16x16x32_bf16 v[80:83], v[84:87], v[72:75], v[80:83]
    v_mfma_f32_16x16x32_bf16 v[80:83], v[84:87], v[76:79], v[80:83]
    s_nop 7
    s_mov_b64 exec, s[78:79]
    ds_write_b32 v88, v80 offset:512
    ds_write_b32 v88, v81 offset:576
    s_mov_b64 exec, -1
    s_waitcnt lgkmcnt(0)
L_p4_cs23_1908:
    s_add_u32 m0, s48, 8192
    s_add_u32 s49, s100, 57344
    buffer_load_dwordx4 v1, s[24:27], s49 offen sc1 lds
    s_add_u32 m0, s48, 12288
    s_add_u32 s49, s100, 61440
    buffer_load_dwordx4 v1, s[24:27], s49 offen sc1 lds
    s_barrier
    s_add_u32 m0, s48, 16384
    s_add_u32 s49, s100, 65536
    buffer_load_dwordx4 v1, s[24:27], s49 offen sc1 lds
    s_add_u32 m0, s48, 20480
    s_add_u32 s49, s100, 69632
    buffer_load_dwordx4 v1, s[24:27], s49 offen sc1 lds
    s_add_u32 m0, s48, 24576
    s_add_u32 s49, s100, 73728
    buffer_load_dwordx4 v1, s[24:27], s49 offen sc1 lds
    s_add_u32 m0, s48, 28672
    s_add_u32 s49, s100, 77824
    buffer_load_dwordx4 v1, s[24:27], s49 offen sc1 lds
    s_add_u32 m0, s48, 32768
    s_add_u32 s49, s100, 81920
    buffer_load_dwordx4 v1, s[24:27], s49 offen sc1 lds
    s_add_u32 m0, s48, 36864
    s_add_u32 s49, s100, 86016
    buffer_load_dwordx4 v1, s[24:27], s49 offen sc1 lds
    s_add_u32 m0, s48, 90112
    s_add_u32 s49, s100, 90112
    buffer_load_dwordx4 v1, s[24:27], s49 offen sc1 lds
    s_add_u32 m0, s48, 94208
    s_add_u32 s49, s100, 94208
    buffer_load_dwordx4 v1, s[24:27], s49 offen sc1 lds
    s_barrier
    s_add_u32 m0, s48, 98304
    s_add_u32 s49, s100, 98304
    buffer_load_dwordx4 v1, s[24:27], s49 offen sc1 lds
    s_add_u32 m0, s48, 102400
    s_add_u32 s49, s100, 102400
    buffer_load_dwordx4 v1, s[24:27], s49 offen sc1 lds
    s_add_u32 m0, s48, 106496
    s_add_u32 s49, s100, 106496
    buffer_load_dwordx4 v1, s[24:27], s49 offen sc1 lds
    s_add_u32 m0, s48, 110592
    s_add_u32 s49, s100, 110592
    buffer_load_dwordx4 v1, s[24:27], s49 offen sc1 lds
    s_add_u32 m0, s48, 114688
    s_add_u32 s49, s100, 114688
    buffer_load_dwordx4 v1, s[24:27], s49 offen sc1 lds
    s_add_u32 m0, s48, 118784
    s_add_u32 s49, s100, 118784
    buffer_load_dwordx4 v1, s[24:27], s49 offen sc1 lds
    s_add_u32 m0, s48, 122880
    s_add_u32 s49, s100, 122880
    buffer_load_dwordx4 v1, s[24:27], s49 offen sc1 lds
    s_add_u32 m0, s48, 126976
    s_add_u32 s49, s100, 126976
    buffer_load_dwordx4 v1, s[24:27], s49 offen sc1 lds
    s_barrier
    s_branch L_l_p5
L_l_p4b:
    s_add_u32 m0, s48, 90112
    s_add_u32 s49, s53, 0
    buffer_load_dwordx4 v1, s[24:27], s49 offen sc1 lds
    s_add_u32 m0, s48, 94208
    s_add_u32 s49, s53, 2048
    buffer_load_dwordx4 v1, s[24:27], s49 offen sc1 lds
    s_add_u32 m0, s48, 98304
    s_add_u32 s49, s53, 4096
    buffer_load_dwordx4 v1, s[24:27], s49 offen sc1 lds
    s_add_u32 m0, s48, 102400
    s_add_u32 s49, s53, 6144
    buffer_load_dwordx4 v1, s[24:27], s49 offen sc1 lds
    s_add_u32 m0, s48, 106496
    s_add_u32 s49, s53, 8192
    buffer_load_dwordx4 v1, s[24:27], s49 offen sc1 lds
    s_add_u32 m0, s48, 110592
    s_add_u32 s49, s53, 10240
    buffer_load_dwordx4 v1, s[24:27], s49 offen sc1 lds
    s_add_u32 m0, s48, 114688
    s_add_u32 s49, s53, 12288
    buffer_load_dwordx4 v1, s[24:27], s49 offen sc1 lds
    s_add_u32 m0, s48, 118784
    s_add_u32 s49, s53, 14336
    buffer_load_dwordx4 v1, s[24:27], s49 offen sc1 lds
    s_add_u32 m0, s48, 122880
    s_add_u32 s49, s53, 16384
    buffer_load_dwordx4 v1, s[24:27], s49 offen sc1 lds
    s_add_u32 m0, s48, 126976
    s_add_u32 s49, s53, 18432
    buffer_load_dwordx4 v1, s[24:27], s49 offen sc1 lds
    s_add_u32 m0, s48, 131072
    s_add_u32 s49, s53, 20480
    buffer_load_dwordx4 v1, s[24:27], s49 offen sc1 lds
    s_add_u32 m0, s48, 135168
    s_add_u32 s49, s53, 22528
    buffer_load_dwordx4 v1, s[24:27], s49 offen sc1 lds
    s_waitcnt vmcnt(10)
    s_barrier
    s_add_u32 m0, s48, 139264
    s_add_u32 s49, s53, 24576
    buffer_load_dwordx4 v1, s[24:27], s49 offen sc1 lds
    s_add_u32 m0, s48, 143360
    s_add_u32 s49, s53, 26624
    buffer_load_dwordx4 v1, s[24:27], s49 offen sc1 lds
    s_waitcnt vmcnt(10)
    s_barrier
    s_add_u32 m0, s48, 147456
    s_add_u32 s49, s53, 28672
    buffer_load_dwordx4 v1, s[24:27], s49 offen sc1 lds
    s_add_u32 m0, s48, 151552
    s_add_u32 s49, s53, 30720
    buffer_load_dwordx4 v1, s[24:27], s49 offen sc1 lds
    s_waitcnt vmcnt(10)
    s_barrier
    s_lshl_b32 s50, s42, 12
    s_add_u32 s50, s50, s59
    buffer_load_dwordx4 v[32:35], v1, s[24:27], s50 offen offset:0 sc1
    buffer_load_dwordx4 v[36:39], v1, s[24:27], s50 offen offset:1024 sc1
    buffer_load_dwordx4 v[40:43], v1, s[24:27], s50 offen offset:2048 sc1
    buffer_load_dwordx4 v[44:47], v1, s[24:27], s50 offen offset:3072 sc1
    s_waitcnt vmcnt(12)
    s_barrier
    s_add_u32 m0, s48, 0
    s_add_u32 s49, s56, 90112
    buffer_load_dwordx4 v1, s[24:27], s49 offen sc1 lds
    s_add_u32 m0, s48, 4096
    s_add_u32 s49, s56, 94208
    buffer_load_dwordx4 v1, s[24:27], s49 offen sc1 lds
    s_waitcnt vmcnt(12)
    s_barrier
    s_add_u32 m0, s48, 8192
    s_add_u32 s49, s56, 98304
    buffer_load_dwordx4 v1, s[24:27], s49 offen sc1 lds
    s_add_u32 m0, s48, 12288
    s_add_u32 s49, s56, 102400
    buffer_load_dwordx4 v1, s[24:27], s49 offen sc1 lds
    s_waitcnt vmcnt(12)
    s_barrier
    s_add_u32 m0, s48, 16384
    s_add_u32 s49, s56, 106496
    buffer_load_dwordx4 v1, s[24:27], s49 offen sc1 lds
    s_add_u32 m0, s48, 20480
    s_add_u32 s49, s56, 110592
    buffer_load_dwordx4 v1, s[24:27], s49 offen sc1 lds
    s_waitcnt vmcnt(12)
    s_barrier
    s_add_u32 m0, s48, 24576
    s_add_u32 s49, s56, 114688
    buffer_load_dwordx4 v1, s[24:27], s49 offen sc1 lds
    s_add_u32 m0, s48, 28672
    s_add_u32 s49, s56, 118784
    buffer_load_dwordx4 v1, s[24:27], s49 offen sc1 lds
    s_waitcnt vmcnt(8)
    v_add_f32 v32, v32, v40
    v_add_f32 v33, v33, v41
    v_add_f32 v34, v34, v42
    v_add_f32 v35, v35, v43
    v_add_f32 v36, v36, v44
    v_add_f32 v37, v37, v45
    v_add_f32 v38, v38, v46
    v_add_f32 v39, v39, v47
    v_add_f32 v32, v32, v36
    v_add_f32 v33, v33, v37
    v_add_f32 v34, v34, v38
    v_add_f32 v35, v35, v39
    v_add_f32 v32, v32, v34
    v_add_f32 v33, v33, v35
    v_add_f32 v32, v32, v33
    s_barrier
    s_add_u32 m0, s48, 32768
    s_add_u32 s49, s56, 122880
    buffer_load_dwordx4 v1, s[24:27], s49 offen sc1 lds
    s_add_u32 m0, s48, 36864
    s_add_u32 s49, s56, 126976
    buffer_load_dwordx4 v1, s[24:27], s49 offen sc1 lds
    v_mov_b32 v48, v32
    v_cmp_gt_u32 s[70:71], 32, v0
    s_nop 0
    v_permlane32_swap_b32 v32, v48
    v_mul_f32 v32, s82, v32
    v_mul_f32 v48, s82, v48
    v_fma_f32 v48, -v32, v32, v48
    v_max_f32 v48, 0, v48
    v_add_f32 v49, s83, v48
    v_rsq_f32 v49, v49
    s_nop 0
    v_mul_f32 v50, v49, v49
    v_mul_f32 v50, v50, v48
    v_add_f32 v50, s83, v50
    v_rsq_f32 v50, v50
    s_nop 0
    v_mul_f32 v49, v49, v50
    v_cndmask_b32 v51, v49, v32, s[70:71]
    ds_write_b32 v9, v51
    s_barrier
    s_add_u32 m0, s48, 90112
    s_add_u32 s49, s56, 131072
    buffer_load_dwordx4 v1, s[24:27], s49 offen sc1 lds
    s_add_u32 m0, s48, 94208
    s_add_u32 s49, s56, 135168
    buffer_load_dwordx4 v1, s[24:27], s49 offen sc1 lds
    s_waitcnt lgkmcnt(0)
    s_barrier
    s_add_u32 m0, s48, 98304
    s_add_u32 s49, s56, 139264
    buffer_load_dwordx4 v1, s[24:27], s49 offen sc1 lds
    s_add_u32 m0, s48, 102400
    s_add_u32 s49, s56, 143360
    buffer_load_dwordx4 v1, s[24:27], s49 offen sc1 lds
    s_barrier
    s_add_u32 m0, s48, 106496
    s_add_u32 s49, s56, 147456
    buffer_load_dwordx4 v1, s[24:27], s49 offen sc1 lds
    s_add_u32 m0, s48, 110592
    s_add_u32 s49, s56, 151552
    buffer_load_dwordx4 v1, s[24:27], s49 offen sc1 lds
    s_waitcnt vmcnt(14)
    s_barrier
    s_add_u32 m0, s48, 114688
    s_add_u32 s49, s56, 155648
    buffer_load_dwordx4 v1, s[24:27], s49 offen sc1 lds
    s_add_u32 m0, s48, 118784
    s_add_u32 s49, s56, 159744
    buffer_load_dwordx4 v1, s[24:27], s49 offen sc1 lds
    s_waitcnt vmcnt(14)
    s_barrier
    s_add_u32 m0, s48, 122880
    s_add_u32 s49, s56, 163840
    buffer_load_dwordx4 v1, s[24:27], s49 offen sc1 lds
    s_add_u32 m0, s48, 126976
    s_add_u32 s49, s56, 167936
    buffer_load_dwordx4 v1, s[24:27], s49 offen sc1 lds
    s_waitcnt vmcnt(14)
    s_barrier
    s_add_u32 m0, s48, 131072
    s_add_u32 s49, s56, 172032
    buffer_load_dwordx4 v1, s[24:27], s49 offen sc1 lds
    s_add_u32 m0, s48, 135168
    s_add_u32 s49, s56, 176128
    buffer_load_dwordx4 v1, s[24:27], s49 offen sc1 lds
    s_waitcnt vmcnt(14)
    s_barrier
    s_add_u32 m0, s48, 139264
    s_add_u32 s49, s56, 180224
    buffer_load_dwordx4 v1, s[24:27], s49 offen sc1 lds
    s_add_u32 m0, s48, 143360
    s_add_u32 s49, s56, 184320
    buffer_load_dwordx4 v1, s[24:27], s49 offen sc1 lds
    s_waitcnt vmcnt(14)
    s_barrier
    s_add_u32 m0, s48, 147456
    s_add_u32 s49, s56, 188416
    buffer_load_dwordx4 v1, s[24:27], s49 offen sc1 lds
    s_add_u32 m0, s48, 151552
    s_add_u32 s49, s56, 192512
    buffer_load_dwordx4 v1, s[24:27], s49 offen sc1 lds
    s_waitcnt vmcnt(14)
    s_barrier
    s_add_u32 m0, s48, 40960
    s_add_u32 s49, s100, 0
    buffer_load_dwordx4 v1, s[24:27], s49 offen sc1 lds
    s_add_u32 m0, s48, 45056
    s_add_u32 s49, s100, 4096
    buffer_load_dwordx4 v1, s[24:27], s49 offen sc1 lds
    s_waitcnt vmcnt(14)
    s_barrier
    s_add_u32 m0, s48, 49152
    s_add_u32 s49, s100, 8192
    buffer_load_dwordx4 v1, s[24:27], s49 offen sc1 lds
    s_add_u32 m0, s48, 53248
    s_add_u32 s49, s100, 12288
    buffer_load_dwordx4 v1, s[24:27], s49 offen sc1 lds
    s_waitcnt vmcnt(14)
    s_barrier
    s_add_u32 m0, s48, 57344
    s_add_u32 s49, s100, 16384
    buffer_load_dwordx4 v1, s[24:27], s49 offen sc1 lds
    s_add_u32 m0, s48, 61440
    s_add_u32 s49, s100, 20480
    buffer_load_dwordx4 v1, s[24:27], s49 offen sc1 lds
    s_waitcnt vmcnt(14)
    s_barrier
    s_add_u32 m0, s48, 65536
    s_add_u32 s49, s100, 24576
    buffer_load_dwordx4 v1, s[24:27], s49 offen sc1 lds
    s_add_u32 m0, s48, 69632
    s_add_u32 s49, s100, 28672
    buffer_load_dwordx4 v1, s[24:27], s49 offen sc1 lds
    s_waitcnt vmcnt(14)
    s_barrier
    s_add_u32 m0, s48, 73728
    s_add_u32 s49, s100, 32768
    buffer_load_dwordx4 v1, s[24:27], s49 offen sc1 lds
    s_add_u32 m0, s48, 77824
    s_add_u32 s49, s100, 36864
    buffer_load_dwordx4 v1, s[24:27], s49 offen sc1 lds
    s_waitcnt vmcnt(14)
    s_barrier
    s_add_u32 m0, s48, 81920
    s_add_u32 s49, s100, 40960
    buffer_load_dwordx4 v1, s[24:27], s49 offen sc1 lds
    s_add_u32 m0, s48, 86016
    s_add_u32 s49, s100, 45056
    buffer_load_dwordx4 v1, s[24:27], s49 offen sc1 lds
    s_waitcnt vmcnt(14)
    s_barrier
    s_add_u32 m0, s48, 0
    s_add_u32 s49, s100, 49152
    buffer_load_dwordx4 v1, s[24:27], s49 offen sc1 lds
    s_add_u32 m0, s48, 4096
    s_add_u32 s49, s100, 53248
    buffer_load_dwordx4 v1, s[24:27], s49 offen sc1 lds
    s_waitcnt vmcnt(14)
    s_barrier
    s_add_u32 m0, s48, 8192
    s_add_u32 s49, s100, 57344
    buffer_load_dwordx4 v1, s[24:27], s49 offen sc1 lds
    s_add_u32 m0, s48, 12288
    s_add_u32 s49, s100, 61440
    buffer_load_dwordx4 v1, s[24:27], s49 offen sc1 lds
    s_barrier
    s_add_u32 m0, s48, 16384
    s_add_u32 s49, s100, 65536
    buffer_load_dwordx4 v1, s[24:27], s49 offen sc1 lds
    s_add_u32 m0, s48, 20480
    s_add_u32 s49, s100, 69632
    buffer_load_dwordx4 v1, s[24:27], s49 offen sc1 lds
    s_add_u32 m0, s48, 24576
    s_add_u32 s49, s100, 73728
    buffer_load_dwordx4 v1, s[24:27], s49 offen sc1 lds
    s_add_u32 m0, s48, 28672
    s_add_u32 s49, s100, 77824
    buffer_load_dwordx4 v1, s[24:27], s49 offen sc1 lds
    s_add_u32 m0, s48, 32768
    s_add_u32 s49, s100, 81920
    buffer_load_dwordx4 v1, s[24:27], s49 offen sc1 lds
    s_add_u32 m0, s48, 36864
    s_add_u32 s49, s100, 86016
    buffer_load_dwordx4 v1, s[24:27], s49 offen sc1 lds
    s_add_u32 m0, s48, 90112
    s_add_u32 s49, s100, 90112
    buffer_load_dwordx4 v1, s[24:27], s49 offen sc1 lds
    s_add_u32 m0, s48, 94208
    s_add_u32 s49, s100, 94208
    buffer_load_dwordx4 v1, s[24:27], s49 offen sc1 lds
    s_barrier
    s_add_u32 m0, s48, 98304
    s_add_u32 s49, s100, 98304
    buffer_load_dwordx4 v1, s[24:27], s49 offen sc1 lds
    s_add_u32 m0, s48, 102400
    s_add_u32 s49, s100, 102400
    buffer_load_dwordx4 v1, s[24:27], s49 offen sc1 lds
    s_add_u32 m0, s48, 106496
    s_add_u32 s49, s100, 106496
    buffer_load_dwordx4 v1, s[24:27], s49 offen sc1 lds
    s_add_u32 m0, s48, 110592
    s_add_u32 s49, s100, 110592
    buffer_load_dwordx4 v1, s[24:27], s49 offen sc1 lds
    s_add_u32 m0, s48, 114688
    s_add_u32 s49, s100, 114688
    buffer_load_dwordx4 v1, s[24:27], s49 offen sc1 lds
    s_add_u32 m0, s48, 118784
    s_add_u32 s49, s100, 118784
    buffer_load_dwordx4 v1, s[24:27], s49 offen sc1 lds
    s_add_u32 m0, s48, 122880
    s_add_u32 s49, s100, 122880
    buffer_load_dwordx4 v1, s[24:27], s49 offen sc1 lds
    s_add_u32 m0, s48, 126976
    s_add_u32 s49, s100, 126976
    buffer_load_dwordx4 v1, s[24:27], s49 offen sc1 lds
    s_barrier
L_l_p5:
    s_waitcnt vmcnt(28)
    s_barrier
    s_waitcnt vmcnt(24)
    s_barrier
    s_add_u32 m0, s48, 131072
    s_add_u32 s49, s100, 131072
    buffer_load_dwordx4 v1, s[24:27], s49 offen sc1 lds
    s_add_u32 m0, s48, 135168
    s_add_u32 s49, s100, 135168
    buffer_load_dwordx4 v1, s[24:27], s49 offen sc1 lds
    s_add_u32 m0, s48, 139264
    s_add_u32 s49, s100, 139264
    buffer_load_dwordx4 v1, s[24:27], s49 offen sc1 lds
    s_waitcnt vmcnt(23)
    s_barrier
    s_add_u32 m0, s48, 143360
    s_add_u32 s49, s100, 143360
    buffer_load_dwordx4 v1, s[24:27], s49 offen sc1 lds
    s_add_u32 m0, s48, 147456
    s_add_u32 s49, s100, 147456
    buffer_load_dwordx4 v1, s[24:27], s49 offen sc1 lds
    s_add_u32 m0, s48, 151552
    s_add_u32 s49, s100, 151552
    buffer_load_dwordx4 v1, s[24:27], s49 offen sc1 lds
    s_waitcnt vmcnt(22)
    s_barrier
    s_waitcnt vmcnt(18)
    s_barrier
    s_add_u32 m0, s48, 40960
    s_add_u32 s49, s100, 155648
    buffer_load_dwordx4 v1, s[24:27], s49 offen sc1 lds
    s_add_u32 m0, s48, 45056
    s_add_u32 s49, s100, 159744
    buffer_load_dwordx4 v1, s[24:27], s49 offen sc1 lds
    s_add_u32 m0, s48, 49152
    s_add_u32 s49, s100, 163840
    buffer_load_dwordx4 v1, s[24:27], s49 offen sc1 lds
    s_waitcnt vmcnt(17)
    s_barrier
    s_add_u32 m0, s48, 53248
    s_add_u32 s49, s100, 167936
    buffer_load_dwordx4 v1, s[24:27], s49 offen sc1 lds
    s_add_u32 m0, s48, 57344
    s_add_u32 s49, s100, 172032
    buffer_load_dwordx4 v1, s[24:27], s49 offen sc1 lds
    s_waitcnt vmcnt(15)
    s_barrier
    s_waitcnt vmcnt(11)
    s_barrier
    s_waitcnt vmcnt(7)
    s_barrier
    s_waitcnt vmcnt(3)
    s_barrier
    s_waitcnt vmcnt(0)
    s_barrier
    s_cmp_lg_u32 s40, 0
    s_cbranch_scc1 L_l_final
    s_add_u32 m0, s48, 65536
    s_add_u32 s49, s55, 0
    buffer_load_dwordx4 v1, s[24:27], s49 offen sc1 lds
    s_add_u32 m0, s48, 69632
    s_add_u32 s49, s55, 4096
    buffer_load_dwordx4 v1, s[24:27], s49 offen sc1 lds
    s_add_u32 m0, s48, 73728
    s_add_u32 s49, s55, 8192
    buffer_load_dwordx4 v1, s[24:27], s49 offen sc1 lds
    s_add_u32 m0, s48, 77824
    s_add_u32 s49, s55, 12288
    buffer_load_dwordx4 v1, s[24:27], s49 offen sc1 lds
    s_add_u32 m0, s48, 81920
    s_add_u32 s49, s55, 16384
    buffer_load_dwordx4 v1, s[24:27], s49 offen sc1 lds
    s_add_u32 m0, s48, 86016
    s_add_u32 s49, s55, 20480
    buffer_load_dwordx4 v1, s[24:27], s49 offen sc1 lds
    s_barrier
    s_add_u32 m0, s48, 90112
    s_add_u32 s49, s55, 24576
    buffer_load_dwordx4 v1, s[24:27], s49 offen sc1 lds
    s_add_u32 m0, s48, 94208
    s_add_u32 s49, s55, 28672
    buffer_load_dwordx4 v1, s[24:27], s49 offen sc1 lds
    s_add_u32 m0, s48, 98304
    s_add_u32 s49, s55, 32768
    buffer_load_dwordx4 v1, s[24:27], s49 offen sc1 lds
    s_add_u32 m0, s48, 102400
    s_add_u32 s49, s55, 36864
    buffer_load_dwordx4 v1, s[24:27], s49 offen sc1 lds
    s_add_u32 m0, s48, 106496
    s_add_u32 s49, s55, 40960
    buffer_load_dwordx4 v1, s[24:27], s49 offen sc1 lds
    s_add_u32 m0, s48, 110592
    s_add_u32 s49, s55, 45056
    buffer_load_dwordx4 v1, s[24:27], s49 offen sc1 lds
    s_barrier
    s_add_u32 m0, s48, 114688
    s_add_u32 s49, s55, 49152
    buffer_load_dwordx4 v1, s[24:27], s49 offen sc1 lds
    s_add_u32 m0, s48, 118784
    s_add_u32 s49, s55, 53248
    buffer_load_dwordx4 v1, s[24:27], s49 offen sc1 lds
    s_add_u32 m0, s48, 122880
    s_add_u32 s49, s55, 57344
    buffer_load_dwordx4 v1, s[24:27], s49 offen sc1 lds
    s_add_u32 m0, s48, 126976
    s_add_u32 s49, s55, 61440
    buffer_load_dwordx4 v1, s[24:27], s49 offen sc1 lds
    s_add_u32 m0, s48, 131072
    s_add_u32 s49, s55, 65536
    buffer_load_dwordx4 v1, s[24:27], s49 offen sc1 lds
    s_add_u32 m0, s48, 135168
    s_add_u32 s49, s55, 69632
    buffer_load_dwordx4 v1, s[24:27], s49 offen sc1 lds
    s_add_u32 m0, s48, 139264
    s_add_u32 s49, s55, 73728
    buffer_load_dwordx4 v1, s[24:27], s49 offen sc1 lds
    s_add_u32 m0, s48, 143360
    s_add_u32 s49, s55, 77824
    buffer_load_dwordx4 v1, s[24:27], s49 offen sc1 lds
    s_add_u32 m0, s48, 147456
    s_add_u32 s49, s55, 81920
    buffer_load_dwordx4 v1, s[24:27], s49 offen sc1 lds
    s_add_u32 m0, s48, 151552
    s_add_u32 s49, s55, 86016
    buffer_load_dwordx4 v1, s[24:27], s49 offen sc1 lds
    s_barrier
    s_mov_b32 s85, 1
    s_add_u32 m0, s48, 0
    s_add_u32 s49, s53, 0
    buffer_load_dwordx4 v1, s[24:27], s49 offen sc1 lds
    s_add_u32 m0, s48, 4096
    s_add_u32 s49, s53, 2048
    buffer_load_dwordx4 v1, s[24:27], s49 offen sc1 lds
    s_add_u32 m0, s48, 8192
    s_add_u32 s49, s53, 4096
    buffer_load_dwordx4 v1, s[24:27], s49 offen sc1 lds
    s_add_u32 m0, s48, 12288
    s_add_u32 s49, s53, 6144
    buffer_load_dwordx4 v1, s[24:27], s49 offen sc1 lds
    s_add_u32 m0, s48, 16384
    s_add_u32 s49, s53, 8192
    buffer_load_dwordx4 v1, s[24:27], s49 offen sc1 lds
    s_add_u32 m0, s48, 20480
    s_add_u32 s49, s53, 10240
    buffer_load_dwordx4 v1, s[24:27], s49 offen sc1 lds
    s_add_u32 m0, s48, 24576
    s_add_u32 s49, s53, 12288
    buffer_load_dwordx4 v1, s[24:27], s49 offen sc1 lds
    s_add_u32 m0, s48, 28672
    s_add_u32 s49, s53, 14336
    buffer_load_dwordx4 v1, s[24:27], s49 offen sc1 lds
    s_add_u32 m0, s48, 32768
    s_add_u32 s49, s53, 16384
    buffer_load_dwordx4 v1, s[24:27], s49 offen sc1 lds
    s_add_u32 m0, s48, 36864
    s_add_u32 s49, s53, 18432
    buffer_load_dwordx4 v1, s[24:27], s49 offen sc1 lds
    s_add_u32 m0, s48, 40960
    s_add_u32 s49, s53, 20480
    buffer_load_dwordx4 v1, s[24:27], s49 offen sc1 lds
    s_add_u32 m0, s48, 45056
    s_add_u32 s49, s53, 22528
    buffer_load_dwordx4 v1, s[24:27], s49 offen sc1 lds
    s_waitcnt vmcnt(10)
    s_barrier
    s_add_u32 m0, s48, 49152
    s_add_u32 s49, s53, 24576
    buffer_load_dwordx4 v1, s[24:27], s49 offen sc1 lds
    s_add_u32 m0, s48, 53248
    s_add_u32 s49, s53, 26624
    buffer_load_dwordx4 v1, s[24:27], s49 offen sc1 lds
    s_waitcnt vmcnt(10)
    s_barrier
    s_add_u32 m0, s48, 57344
    s_add_u32 s49, s53, 28672
    buffer_load_dwordx4 v1, s[24:27], s49 offen sc1 lds
    s_add_u32 m0, s48, 61440
    s_add_u32 s49, s53, 30720
    buffer_load_dwordx4 v1, s[24:27], s49 offen sc1 lds
    s_waitcnt vmcnt(10)
    s_barrier
    s_lshl_b32 s50, s42, 12
    s_add_u32 s50, s50, s59
    buffer_load_dwordx4 v[32:35], v1, s[24:27], s50 offen offset:0 sc1
    buffer_load_dwordx4 v[36:39], v1, s[24:27], s50 offen offset:1024 sc1
    buffer_load_dwordx4 v[40:43], v1, s[24:27], s50 offen offset:2048 sc1
    buffer_load_dwordx4 v[44:47], v1, s[24:27], s50 offen offset:3072 sc1
    s_waitcnt vmcnt(12)
    s_barrier
    s_add_u32 m0, s48, 65536
    s_add_u32 s49, s55, 90112
    buffer_load_dwordx4 v1, s[24:27], s49 offen sc1 lds
    s_add_u32 m0, s48, 69632
    s_add_u32 s49, s55, 94208
    buffer_load_dwordx4 v1, s[24:27], s49 offen sc1 lds
    s_waitcnt vmcnt(12)
    s_barrier
    s_add_u32 m0, s48, 73728
    s_add_u32 s49, s55, 98304
    buffer_load_dwordx4 v1, s[24:27], s49 offen sc1 lds
    s_add_u32 m0, s48, 77824
    s_add_u32 s49, s55, 102400
    buffer_load_dwordx4 v1, s[24:27], s49 offen sc1 lds
    s_waitcnt vmcnt(12)
    s_barrier
    s_add_u32 m0, s48, 81920
    s_add_u32 s49, s55, 106496
    buffer_load_dwordx4 v1, s[24:27], s49 offen sc1 lds
    s_add_u32 m0, s48, 86016
    s_add_u32 s49, s55, 110592
    buffer_load_dwordx4 v1, s[24:27], s49 offen sc1 lds
    s_waitcnt vmcnt(12)
    s_barrier
    s_add_u32 m0, s48, 90112
    s_add_u32 s49, s55, 114688
    buffer_load_dwordx4 v1, s[24:27], s49 offen sc1 lds
    s_add_u32 m0, s48, 94208
    s_add_u32 s49, s55, 118784
    buffer_load_dwordx4 v1, s[24:27], s49 offen sc1 lds
    s_waitcnt vmcnt(8)
    v_add_f32 v32, v32, v40
    v_add_f32 v33, v33, v41
    v_add_f32 v34, v34, v42
    v_add_f32 v35, v35, v43
    v_add_f32 v36, v36, v44
    v_add_f32 v37, v37, v45
    v_add_f32 v38, v38, v46
    v_add_f32 v39, v39, v47
    v_add_f32 v32, v32, v36
    v_add_f32 v33, v33, v37
    v_add_f32 v34, v34, v38
    v_add_f32 v35, v35, v39
    v_add_f32 v32, v32, v34
    v_add_f32 v33, v33, v35
    v_add_f32 v32, v32, v33
    s_barrier
    s_add_u32 m0, s48, 98304
    s_add_u32 s49, s55, 122880
    buffer_load_dwordx4 v1, s[24:27], s49 offen sc1 lds
    s_add_u32 m0, s48, 102400
    s_add_u32 s49, s55, 126976
    buffer_load_dwordx4 v1, s[24:27], s49 offen sc1 lds
    v_mov_b32 v48, v32
    v_cmp_gt_u32 s[70:71], 32, v0
    s_nop 0
    v_permlane32_swap_b32 v32, v48
    v_mul_f32 v32, s82, v32
    v_mul_f32 v48, s82, v48
    v_fma_f32 v48, -v32, v32, v48
    v_max_f32 v48, 0, v48
    v_add_f32 v49, s83, v48
    v_rsq_f32 v49, v49
    s_nop 0
    v_cndmask_b32 v51, v49, v32, s[70:71]
    ds_write_b32 v9, v51
    s_barrier
    s_add_u32 m0, s48, 0
    s_add_u32 s49, s55, 131072
    buffer_load_dwordx4 v1, s[24:27], s49 offen sc1 lds
    s_add_u32 m0, s48, 4096
    s_add_u32 s49, s55, 135168
    buffer_load_dwordx4 v1, s[24:27], s49 offen sc1 lds
    s_waitcnt lgkmcnt(0)
    s_barrier
    s_add_u32 m0, s48, 8192
    s_add_u32 s49, s55, 139264
    buffer_load_dwordx4 v1, s[24:27], s49 offen sc1 lds
    s_add_u32 m0, s48, 12288
    s_add_u32 s49, s55, 143360
    buffer_load_dwordx4 v1, s[24:27], s49 offen sc1 lds
    s_barrier
    s_add_u32 m0, s48, 16384
    s_add_u32 s49, s55, 147456
    buffer_load_dwordx4 v1, s[24:27], s49 offen sc1 lds
    s_add_u32 m0, s48, 20480
    s_add_u32 s49, s55, 151552
    buffer_load_dwordx4 v1, s[24:27], s49 offen sc1 lds
    s_waitcnt vmcnt(14)
    s_barrier
    s_add_u32 m0, s48, 24576
    s_add_u32 s49, s55, 155648
    buffer_load_dwordx4 v1, s[24:27], s49 offen sc1 lds
    s_add_u32 m0, s48, 28672
    s_add_u32 s49, s55, 159744
    buffer_load_dwordx4 v1, s[24:27], s49 offen sc1 lds
    s_waitcnt vmcnt(14)
    s_barrier
    s_add_u32 m0, s48, 40960
    s_add_u32 s49, s55, 163840
    buffer_load_dwordx4 v1, s[24:27], s49 offen sc1 lds
    s_add_u32 m0, s48, 45056
    s_add_u32 s49, s55, 167936
    buffer_load_dwordx4 v1, s[24:27], s49 offen sc1 lds
    s_waitcnt vmcnt(14)
    s_barrier
    s_add_u32 m0, s48, 49152
    s_add_u32 s49, s55, 172032
    buffer_load_dwordx4 v1, s[24:27], s49 offen sc1 lds
    s_add_u32 m0, s48, 53248
    s_add_u32 s49, s55, 176128
    buffer_load_dwordx4 v1, s[24:27], s49 offen sc1 lds
    s_waitcnt vmcnt(14)
    s_barrier
    s_add_u32 m0, s48, 57344
    s_add_u32 s49, s55, 180224
    buffer_load_dwordx4 v1, s[24:27], s49 offen sc1 lds
    s_add_u32 m0, s48, 61440
    s_add_u32 s49, s55, 184320
    buffer_load_dwordx4 v1, s[24:27], s49 offen sc1 lds
    s_waitcnt vmcnt(14)
    s_barrier
    s_add_u32 m0, s48, 65536
    s_add_u32 s49, s55, 188416
    buffer_load_dwordx4 v1, s[24:27], s49 offen sc1 lds
    s_add_u32 m0, s48, 69632
    s_add_u32 s49, s55, 192512
    buffer_load_dwordx4 v1, s[24:27], s49 offen sc1 lds
    s_waitcnt vmcnt(14)
    s_barrier
    s_add_u32 m0, s48, 90112
    s_add_u32 s49, s57, 0
    buffer_load_dwordx4 v1, s[24:27], s49 offen sc1 lds
    s_add_u32 m0, s48, 94208
    s_add_u32 s49, s57, 4096
    buffer_load_dwordx4 v1, s[24:27], s49 offen sc1 lds
    s_waitcnt vmcnt(14)
    s_barrier
    s_add_u32 m0, s48, 98304
    s_add_u32 s49, s57, 8192
    buffer_load_dwordx4 v1, s[24:27], s49 offen sc1 lds
    s_add_u32 m0, s48, 102400
    s_add_u32 s49, s57, 12288
    buffer_load_dwordx4 v1, s[24:27], s49 offen sc1 lds
    s_waitcnt vmcnt(14)
    s_barrier
    s_add_u32 m0, s48, 106496
    s_add_u32 s49, s57, 16384
    buffer_load_dwordx4 v1, s[24:27], s49 offen sc1 lds
    s_add_u32 m0, s48, 110592
    s_add_u32 s49, s57, 20480
    buffer_load_dwordx4 v1, s[24:27], s49 offen sc1 lds
    s_waitcnt vmcnt(14)
    s_barrier
    s_add_u32 m0, s48, 114688
    s_add_u32 s49, s57, 24576
    buffer_load_dwordx4 v1, s[24:27], s49 offen sc1 lds
    s_add_u32 m0, s48, 118784
    s_add_u32 s49, s57, 28672
    buffer_load_dwordx4 v1, s[24:27], s49 offen sc1 lds
    s_waitcnt vmcnt(14)
    s_barrier
    s_add_u32 m0, s48, 122880
    s_add_u32 s49, s57, 32768
    buffer_load_dwordx4 v1, s[24:27], s49 offen sc1 lds
    s_add_u32 m0, s48, 126976
    s_add_u32 s49, s57, 36864
    buffer_load_dwordx4 v1, s[24:27], s49 offen sc1 lds
    s_waitcnt vmcnt(14)
    s_barrier
    s_add_u32 m0, s48, 131072
    s_add_u32 s49, s57, 40960
    buffer_load_dwordx4 v1, s[24:27], s49 offen sc1 lds
    s_add_u32 m0, s48, 135168
    s_add_u32 s49, s57, 45056
    buffer_load_dwordx4 v1, s[24:27], s49 offen sc1 lds
    s_waitcnt vmcnt(14)
    s_barrier
    s_cmp_lg_u32 s38, 4
    s_cbranch_scc1 L_p1b_kf_skip
    s_lshl_b32 s50, s36, 3
    s_add_u32 s50, s50, s37
    s_lshl_b32 s50, s50, 7
    s_add_u32 s50, s50, 8192
    s_add_u32 s74, s85, 1
    s_add_u32 s74, s74, s87
    v_mov_b32 v21, s74
    v_mov_b32 v22, s50
    s_mov_b64 s[70:71], exec
    s_mov_b64 exec, 1
    buffer_store_dword v21, v22, s[24:27], 0 offen sc1
    s_mov_b64 exec, s[70:71]
L_p1b_kf_skip:
    s_add_u32 m0, s48, 139264
    s_add_u32 s49, s57, 49152
    buffer_load_dwordx4 v1, s[24:27], s49 offen sc1 lds
    s_add_u32 m0, s48, 143360
    s_add_u32 s49, s57, 53248
    buffer_load_dwordx4 v1, s[24:27], s49 offen sc1 lds
    s_waitcnt vmcnt(14)
    s_barrier
    s_add_u32 m0, s48, 147456
    s_add_u32 s49, s57, 57344
    buffer_load_dwordx4 v1, s[24:27], s49 offen sc1 lds
    s_add_u32 m0, s48, 151552
    s_add_u32 s49, s57, 61440
    buffer_load_dwordx4 v1, s[24:27], s49 offen sc1 lds
    s_barrier
    s_cmp_lg_u32 s38, 4
    s_cbranch_scc1 L_p1b_kw_skip
    v_and_b32 v22, 3, v0
    v_add_u32 v22, 1, v22
    v_sub_u32 v22, s36, v22
    v_cmp_gt_i32 vcc, 0, v22
    v_mov_b32 v23, s36
    s_nop 1
    v_cndmask_b32 v22, v22, v23, vcc
    v_lshlrev_b32 v22, 3, v22
    v_add_u32 v22, s37, v22
    v_lshlrev_b32 v22, 7, v22
    v_add_u32 v22, 8192, v22
    s_add_u32 s74, s85, 1
    s_add_u32 s74, s74, s87
    s_mov_b32 s60, 400000
L_p1b_kp:
    buffer_load_dword v20, v22, s[24:27], 0 offen sc1
    s_waitcnt vmcnt(0)
    v_subrev_u32 v20, s74, v20
    v_cmp_le_u32 vcc, 8, v20
    s_sub_u32 s60, s60, 1
    s_cbranch_scc1 L_p1b_kp_x
    s_cbranch_vccnz L_p1b_kp
L_p1b_kp_x:
L_p1b_kw_skip:
    s_barrier
    s_mov_b32 s40, 1
    s_branch L_l_loop
L_l_final:
    s_barrier
    s_waitcnt vmcnt(0)
    s_endpgm
L_attn:
    ds_read_b128 v[32:35], v210
    ds_read_b128 v[36:39], v208 offset:32768
    ds_read_b128 v[40:43], v208 offset:28672
    s_waitcnt lgkmcnt(2)
    s_waitcnt lgkmcnt(1)
    v_mfma_f32_32x32x16_bf16 v[80:95], v[36:39], v[32:35], v[128:143]
    ds_read_b128 v[36:39], v208 offset:24576
    s_waitcnt lgkmcnt(1)
    v_mfma_f32_32x32x16_bf16 v[64:79], v[40:43], v[32:35], 0
    ds_read_b128 v[40:43], v208 offset:20480
    s_nop 5
    s_waitcnt lgkmcnt(1)
    v_mfma_f32_32x32x16_bf16 v[48:63], v[36:39], v[32:35], 0
    ds_read_b128 v[36:39], v208 offset:16384
    s_nop 1
    v_max3_f32 v120, v80, v81, v82
    v_max_f32 v120, v120, v83
    v_max3_f32 v120, v120, v84, v85
    v_max3_f32 v120, v120, v86, v87
    v_max3_f32 v120, v120, v88, v89
    v_max3_f32 v120, v120, v90, v91
    v_max3_f32 v120, v120, v92, v93
    v_max3_f32 v120, v120, v94, v95
    s_cmp_eq_u32 s72, 8
    s_cbranch_scc1 L_at_p1done
    s_waitcnt lgkmcnt(1)
    v_mfma_f32_32x32x16_bf16 v[80:95], v[40:43], v[32:35], 0
    ds_read_b128 v[40:43], v208 offset:12288
    v_max3_f32 v120, v120, v64, v65
    v_max3_f32 v120, v120, v66, v67
    v_max3_f32 v120, v120, v68, v69
    v_max3_f32 v120, v120, v70, v71
    v_max3_f32 v120, v120, v72, v73
    v_max3_f32 v120, v120, v74, v75
    v_max3_f32 v120, v120, v76, v77
    v_max3_f32 v120, v120, v78, v79
    s_cmp_eq_u32 s72, 7
    s_cbranch_scc1 L_at_p1done
    s_waitcnt lgkmcnt(1)
    v_mfma_f32_32x32x16_bf16 v[64:79], v[36:39], v[32:35], 0
    ds_read_b128 v[36:39], v208 offset:8192
    v_max3_f32 v120, v120, v48, v49
    v_max3_f32 v120, v120, v50, v51
    v_max3_f32 v120, v120, v52, v53
    v_max3_f32 v120, v120, v54, v55
    v_max3_f32 v120, v120, v56, v57
    v_max3_f32 v120, v120, v58, v59
    v_max3_f32 v120, v120, v60, v61
    v_max3_f32 v120, v120, v62, v63
    s_cmp_eq_u32 s72, 6
    s_cbranch_scc1 L_at_p1done
    s_waitcnt lgkmcnt(1)
    v_mfma_f32_32x32x16_bf16 v[48:63], v[40:43], v[32:35], 0
    ds_read_b128 v[40:43], v208 offset:4096
    v_max3_f32 v120, v120, v80, v81
    v_max3_f32 v120, v120, v82, v83
    v_max3_f32 v120, v120, v84, v85
    v_max3_f32 v120, v120, v86, v87
    v_max3_f32 v120, v120, v88, v89
    v_max3_f32 v120, v120, v90, v91
    v_max3_f32 v120, v120, v92, v93
    v_max3_f32 v120, v120, v94, v95
    s_cmp_eq_u32 s72, 5
    s_cbranch_scc1 L_at_p1done
    s_waitcnt lgkmcnt(1)
    v_mfma_f32_32x32x16_bf16 v[80:95], v[36:39], v[32:35], 0
    ds_read_b128 v[36:39], v208 offset:0
    v_max3_f32 v120, v120, v64, v65
    v_max3_f32 v120, v120, v66, v67
    v_max3_f32 v120, v120, v68, v69
    v_max3_f32 v120, v120, v70, v71
    v_max3_f32 v120, v120, v72, v73
    v_max3_f32 v120, v120, v74, v75
    v_max3_f32 v120, v120, v76, v77
    v_max3_f32 v120, v120, v78, v79
    s_cmp_eq_u32 s72, 4
    s_cbranch_scc1 L_at_p1done
    s_waitcnt lgkmcnt(1)
    v_mfma_f32_32x32x16_bf16 v[64:79], v[40:43], v[32:35], 0
    v_max3_f32 v120, v120, v48, v49
    v_max3_f32 v120, v120, v50, v51
    v_max3_f32 v120, v120, v52, v53
    v_max3_f32 v120, v120, v54, v55
    v_max3_f32 v120, v120, v56, v57
    v_max3_f32 v120, v120, v58, v59
    v_max3_f32 v120, v120, v60, v61
    v_max3_f32 v120, v120, v62, v63
    s_cmp_eq_u32 s72, 3
    s_cbranch_scc1 L_at_p1done
    s_waitcnt lgkmcnt(0)
    v_mfma_f32_32x32x16_bf16 v[48:63], v[36:39], v[32:35], v[144:159]
    v_max3_f32 v120, v120, v80, v81
    v_max3_f32 v120, v120, v82, v83
    v_max3_f32 v120, v120, v84, v85
    v_max3_f32 v120, v120, v86, v87
    v_max3_f32 v120, v120, v88, v89
    v_max3_f32 v120, v120, v90, v91
    v_max3_f32 v120, v120, v92, v93
    v_max3_f32 v120, v120, v94, v95
    s_cmp_eq_u32 s72, 2
    s_cbranch_scc1 L_at_p1done
    s_nop 1
    v_max3_f32 v120, v120, v64, v65
    v_max3_f32 v120, v120, v66, v67
    v_max3_f32 v120, v120, v68, v69
    v_max3_f32 v120, v120, v70, v71
    v_max3_f32 v120, v120, v72, v73
    v_max3_f32 v120, v120, v74, v75
    v_max3_f32 v120, v120, v76, v77
    v_max3_f32 v120, v120, v78, v79
    s_cmp_eq_u32 s72, 1
    s_cbranch_scc1 L_at_p1done
    s_nop 2
    v_max3_f32 v120, v120, v48, v49
    v_max3_f32 v120, v120, v50, v51
    v_max3_f32 v120, v120, v52, v53
    v_max3_f32 v120, v120, v54, v55
    v_max3_f32 v120, v120, v56, v57
    v_max3_f32 v120, v120, v58, v59
    v_max3_f32 v120, v120, v60, v61
    v_max3_f32 v120, v120, v62, v63
L_at_p1done:
    s_waitcnt lgkmcnt(0)
    v_mov_b32 v121, v120
    ds_read_b128 v[36:39], v208 offset:32768
    ds_read_b128 v[40:43], v208 offset:28672
    v_permlane32_swap_b32 v120, v121
    v_max_f32 v120, v120, v121
    v_sub_f32 v120, 0, v120
    s_nop 7
    v_pk_add_f32 v[176:177], v[128:129], v[120:121] op_sel_hi:[1,0]
    v_pk_add_f32 v[178:179], v[130:131], v[120:121] op_sel_hi:[1,0]
    v_pk_add_f32 v[180:181], v[132:133], v[120:121] op_sel_hi:[1,0]
    v_pk_add_f32 v[182:183], v[134:135], v[120:121] op_sel_hi:[1,0]
    v_pk_add_f32 v[184:185], v[136:137], v[120:121] op_sel_hi:[1,0]
    v_pk_add_f32 v[186:187], v[138:139], v[120:121] op_sel_hi:[1,0]
    v_pk_add_f32 v[188:189], v[140:141], v[120:121] op_sel_hi:[1,0]
    v_pk_add_f32 v[190:191], v[142:143], v[120:121] op_sel_hi:[1,0]
    v_mov_b32 v121, v120
    v_pk_add_f32 v[192:193], v[144:145], v[120:121] op_sel_hi:[1,0]
    v_pk_add_f32 v[194:195], v[146:147], v[120:121] op_sel_hi:[1,0]
    v_pk_add_f32 v[196:197], v[148:149], v[120:121] op_sel_hi:[1,0]
    v_pk_add_f32 v[198:199], v[150:151], v[120:121] op_sel_hi:[1,0]
    v_pk_add_f32 v[200:201], v[152:153], v[120:121] op_sel_hi:[1,0]
    v_pk_add_f32 v[202:203], v[154:155], v[120:121] op_sel_hi:[1,0]
    v_pk_add_f32 v[204:205], v[156:157], v[120:121] op_sel_hi:[1,0]
    v_pk_add_f32 v[206:207], v[158:159], v[120:121] op_sel_hi:[1,0]
    v_pk_mul_f32 v[160:161], v[120:121], 1.0 op_sel_hi:[1,0]
    v_pk_mul_f32 v[162:163], v[120:121], 1.0 op_sel_hi:[1,0]
    v_pk_mul_f32 v[164:165], v[120:121], 1.0 op_sel_hi:[1,0]
    v_pk_mul_f32 v[166:167], v[120:121], 1.0 op_sel_hi:[1,0]
    v_pk_mul_f32 v[168:169], v[120:121], 1.0 op_sel_hi:[1,0]
    v_pk_mul_f32 v[170:171], v[120:121], 1.0 op_sel_hi:[1,0]
    v_pk_mul_f32 v[172:173], v[120:121], 1.0 op_sel_hi:[1,0]
    v_pk_mul_f32 v[174:175], v[120:121], 1.0 op_sel_hi:[1,0]
    s_waitcnt lgkmcnt(1)
    v_mfma_f32_32x32x16_bf16 v[48:63], v[36:39], v[32:35], v[176:191]
    ds_read_b128 v[36:39], v208 offset:24576
    s_cmp_lt_u32 s38, 4
    s_cbranch_scc1 L_at_vw0
    s_cmp_lg_u32 s40, 0
    s_cbranch_scc1 L_at_vw6
    s_cmp_eq_u32 s38, 4
    s_cbranch_scc1 L_at_vw6
    s_waitcnt vmcnt(4)
    s_branch L_at_vw1
L_at_vw6:
    s_waitcnt vmcnt(2)
    s_branch L_at_vw1
L_at_vw0:
    s_waitcnt vmcnt(0)
L_at_vw1:
    s_barrier
    s_mov_b64 exec, s[68:69]
    ds_read_b128 v[104:107], v209 offset:32768
    ds_read_b128 v[108:111], v209 offset:33280
    s_mov_b64 exec, -1
    s_nop 4
    s_setprio 3
    v_exp_f32 v48, v48
    v_exp_f32 v49, v49
    v_exp_f32 v50, v50
    v_exp_f32 v51, v51
    s_waitcnt lgkmcnt(3)
    v_mfma_f32_32x32x16_bf16 v[64:79], v[40:43], v[32:35], v[160:175]
    ds_read_b128 v[40:43], v208 offset:20480
    v_exp_f32 v52, v52
    v_exp_f32 v53, v53
    v_exp_f32 v54, v54
    v_exp_f32 v55, v55
    v_cvt_pk_bf16_f32 v96, v48, v49
    v_cvt_pk_bf16_f32 v97, v50, v51
    v_cvt_pk_bf16_f32 v98, v52, v53
    v_cvt_pk_bf16_f32 v99, v54, v55
    s_waitcnt lgkmcnt(1)
    v_exp_f32 v56, v56
    v_mfma_f32_32x32x16_bf16 v[80:95], v[104:107], v[96:99], 0
    v_exp_f32 v57, v57
    v_exp_f32 v58, v58
    v_exp_f32 v59, v59
    v_exp_f32 v60, v60
    v_exp_f32 v61, v61
    v_exp_f32 v62, v62
    v_exp_f32 v63, v63
    s_mov_b64 exec, s[68:69]
    ds_read_b128 v[112:115], v209 offset:28672
    ds_read_b128 v[116:119], v209 offset:29184
    s_mov_b64 exec, -1
    v_cvt_pk_bf16_f32 v100, v56, v57
    v_cvt_pk_bf16_f32 v101, v58, v59
    v_cvt_pk_bf16_f32 v102, v60, v61
    v_cvt_pk_bf16_f32 v103, v62, v63
    s_cmp_eq_u32 s72, 8
    s_nop 0
    v_mfma_f32_32x32x16_bf16 v[80:95], v[108:111], v[100:103], v[80:95]
    s_cbranch_scc1 L_at_p2done
    v_exp_f32 v64, v64
    v_exp_f32 v65, v65
    v_exp_f32 v66, v66
    v_exp_f32 v67, v67
    v_mfma_f32_32x32x16_bf16 v[48:63], v[36:39], v[32:35], v[160:175]
    ds_read_b128 v[36:39], v208 offset:16384
    v_exp_f32 v68, v68
    v_exp_f32 v69, v69
    v_exp_f32 v70, v70
    v_exp_f32 v71, v71
    v_cvt_pk_bf16_f32 v96, v64, v65
    v_cvt_pk_bf16_f32 v97, v66, v67
    v_cvt_pk_bf16_f32 v98, v68, v69
    v_cvt_pk_bf16_f32 v99, v70, v71
    s_waitcnt lgkmcnt(1)
    v_exp_f32 v72, v72
    v_mfma_f32_32x32x16_bf16 v[80:95], v[112:115], v[96:99], v[80:95]
    v_exp_f32 v73, v73
    v_exp_f32 v74, v74
    v_exp_f32 v75, v75
    v_exp_f32 v76, v76
    v_exp_f32 v77, v77
    v_exp_f32 v78, v78
    v_exp_f32 v79, v79
    s_mov_b64 exec, s[68:69]
    ds_read_b128 v[104:107], v209 offset:24576
    ds_read_b128 v[108:111], v209 offset:25088
    s_mov_b64 exec, -1
    v_cvt_pk_bf16_f32 v100, v72, v73
    v_cvt_pk_bf16_f32 v101, v74, v75
    v_cvt_pk_bf16_f32 v102, v76, v77
    v_cvt_pk_bf16_f32 v103, v78, v79
    s_cmp_eq_u32 s72, 7
    s_nop 0
    v_mfma_f32_32x32x16_bf16 v[80:95], v[116:119], v[100:103], v[80:95]
    s_cbranch_scc1 L_at_p2done
    s_setprio 2
    v_exp_f32 v48, v48
    v_exp_f32 v49, v49
    v_exp_f32 v50, v50
    v_exp_f32 v51, v51
    v_mfma_f32_32x32x16_bf16 v[64:79], v[40:43], v[32:35], v[160:175]
    ds_read_b128 v[40:43], v208 offset:12288
    v_exp_f32 v52, v52
    v_exp_f32 v53, v53
    v_exp_f32 v54, v54
    v_exp_f32 v55, v55
    v_cvt_pk_bf16_f32 v96, v48, v49
    v_cvt_pk_bf16_f32 v97, v50, v51
    v_cvt_pk_bf16_f32 v98, v52, v53
    v_cvt_pk_bf16_f32 v99, v54, v55
    s_waitcnt lgkmcnt(1)
    v_exp_f32 v56, v56
    v_mfma_f32_32x32x16_bf16 v[80:95], v[104:107], v[96:99], v[80:95]
    v_exp_f32 v57, v57
    v_exp_f32 v58, v58
    v_exp_f32 v59, v59
    v_exp_f32 v60, v60
    v_exp_f32 v61, v61
    v_exp_f32 v62, v62
    v_exp_f32 v63, v63
    s_mov_b64 exec, s[68:69]
    ds_read_b128 v[112:115], v209 offset:20480
    ds_read_b128 v[116:119], v209 offset:20992
    s_mov_b64 exec, -1
    v_cvt_pk_bf16_f32 v100, v56, v57
    v_cvt_pk_bf16_f32 v101, v58, v59
    v_cvt_pk_bf16_f32 v102, v60, v61
    v_cvt_pk_bf16_f32 v103, v62, v63
    s_cmp_eq_u32 s72, 6
    s_nop 0
    v_mfma_f32_32x32x16_bf16 v[80:95], v[108:111], v[100:103], v[80:95]
    s_cbranch_scc1 L_at_p2done
    v_exp_f32 v64, v64
    v_exp_f32 v65, v65
    v_exp_f32 v66, v66
    v_exp_f32 v67, v67
    v_mfma_f32_32x32x16_bf16 v[48:63], v[36:39], v[32:35], v[160:175]
    ds_read_b128 v[36:39], v208 offset:8192
    v_exp_f32 v68, v68
    v_exp_f32 v69, v69
    v_exp_f32 v70, v70
    v_exp_f32 v71, v71
    v_cvt_pk_bf16_f32 v96, v64, v65
    v_cvt_pk_bf16_f32 v97, v66, v67
    v_cvt_pk_bf16_f32 v98, v68, v69
    v_cvt_pk_bf16_f32 v99, v70, v71
    s_waitcnt lgkmcnt(1)
    v_exp_f32 v72, v72
    v_mfma_f32_32x32x16_bf16 v[80:95], v[112:115], v[96:99], v[80:95]
    v_exp_f32 v73, v73
    v_exp_f32 v74, v74
    v_exp_f32 v75, v75
    v_exp_f32 v76, v76
    v_exp_f32 v77, v77
    v_exp_f32 v78, v78
    v_exp_f32 v79, v79
    s_mov_b64 exec, s[68:69]
    ds_read_b128 v[104:107], v209 offset:16384
    ds_read_b128 v[108:111], v209 offset:16896
    s_mov_b64 exec, -1
    v_cvt_pk_bf16_f32 v100, v72, v73
    v_cvt_pk_bf16_f32 v101, v74, v75
    v_cvt_pk_bf16_f32 v102, v76, v77
    v_cvt_pk_bf16_f32 v103, v78, v79
    s_cmp_eq_u32 s72, 5
    s_nop 0
    v_mfma_f32_32x32x16_bf16 v[80:95], v[116:119], v[100:103], v[80:95]
    s_cbranch_scc1 L_at_p2done
    v_exp_f32 v48, v48
    v_exp_f32 v49, v49
    v_exp_f32 v50, v50
    v_exp_f32 v51, v51
    v_mfma_f32_32x32x16_bf16 v[64:79], v[40:43], v[32:35], v[160:175]
    ds_read_b128 v[40:43], v208 offset:4096
    v_exp_f32 v52, v52
    v_exp_f32 v53, v53
    v_exp_f32 v54, v54
    v_exp_f32 v55, v55
    v_cvt_pk_bf16_f32 v96, v48, v49
    v_cvt_pk_bf16_f32 v97, v50, v51
    v_cvt_pk_bf16_f32 v98, v52, v53
    v_cvt_pk_bf16_f32 v99, v54, v55
    s_waitcnt lgkmcnt(1)
    v_exp_f32 v56, v56
    v_mfma_f32_32x32x16_bf16 v[80:95], v[104:107], v[96:99], v[80:95]
    v_exp_f32 v57, v57
    v_exp_f32 v58, v58
    v_exp_f32 v59, v59
    v_exp_f32 v60, v60
    v_exp_f32 v61, v61
    v_exp_f32 v62, v62
    v_exp_f32 v63, v63
    s_mov_b64 exec, s[68:69]
    ds_read_b128 v[112:115], v209 offset:12288
    ds_read_b128 v[116:119], v209 offset:12800
    s_mov_b64 exec, -1
    v_cvt_pk_bf16_f32 v100, v56, v57
    v_cvt_pk_bf16_f32 v101, v58, v59
    v_cvt_pk_bf16_f32 v102, v60, v61
    v_cvt_pk_bf16_f32 v103, v62, v63
    s_cmp_eq_u32 s72, 4
    s_nop 0
    v_mfma_f32_32x32x16_bf16 v[80:95], v[108:111], v[100:103], v[80:95]
    s_cbranch_scc1 L_at_p2done
    s_setprio 1
    v_exp_f32 v64, v64
    v_exp_f32 v65, v65
    v_exp_f32 v66, v66
    v_exp_f32 v67, v67
    v_mfma_f32_32x32x16_bf16 v[48:63], v[36:39], v[32:35], v[160:175]
    ds_read_b128 v[36:39], v208 offset:0
    v_exp_f32 v68, v68
    v_exp_f32 v69, v69
    v_exp_f32 v70, v70
    v_exp_f32 v71, v71
    v_cvt_pk_bf16_f32 v96, v64, v65
    v_cvt_pk_bf16_f32 v97, v66, v67
    v_cvt_pk_bf16_f32 v98, v68, v69
    v_cvt_pk_bf16_f32 v99, v70, v71
    s_waitcnt lgkmcnt(1)
    v_exp_f32 v72, v72
    v_mfma_f32_32x32x16_bf16 v[80:95], v[112:115], v[96:99], v[80:95]
    v_exp_f32 v73, v73
    v_exp_f32 v74, v74
    v_exp_f32 v75, v75
    v_exp_f32 v76, v76
    v_exp_f32 v77, v77
    v_exp_f32 v78, v78
    v_exp_f32 v79, v79
    s_mov_b64 exec, s[68:69]
    ds_read_b128 v[104:107], v209 offset:8192
    ds_read_b128 v[108:111], v209 offset:8704
    s_mov_b64 exec, -1
    v_cvt_pk_bf16_f32 v100, v72, v73
    v_cvt_pk_bf16_f32 v101, v74, v75
    v_cvt_pk_bf16_f32 v102, v76, v77
    v_cvt_pk_bf16_f32 v103, v78, v79
    s_cmp_eq_u32 s72, 3
    s_nop 0
    v_mfma_f32_32x32x16_bf16 v[80:95], v[116:119], v[100:103], v[80:95]
    s_cbranch_scc1 L_at_p2done
    v_exp_f32 v48, v48
    v_exp_f32 v49, v49
    v_exp_f32 v50, v50
    v_exp_f32 v51, v51
    v_mfma_f32_32x32x16_bf16 v[64:79], v[40:43], v[32:35], v[160:175]
    v_exp_f32 v52, v52
    v_exp_f32 v53, v53
    v_exp_f32 v54, v54
    v_exp_f32 v55, v55
    v_cvt_pk_bf16_f32 v96, v48, v49
    v_cvt_pk_bf16_f32 v97, v50, v51
    v_cvt_pk_bf16_f32 v98, v52, v53
    v_cvt_pk_bf16_f32 v99, v54, v55
    s_waitcnt lgkmcnt(0)
    v_exp_f32 v56, v56
    v_mfma_f32_32x32x16_bf16 v[80:95], v[104:107], v[96:99], v[80:95]
    v_exp_f32 v57, v57
    v_exp_f32 v58, v58
    v_exp_f32 v59, v59
    v_exp_f32 v60, v60
    v_exp_f32 v61, v61
    v_exp_f32 v62, v62
    v_exp_f32 v63, v63
    s_mov_b64 exec, s[68:69]
    ds_read_b128 v[112:115], v209 offset:4096
    ds_read_b128 v[116:119], v209 offset:4608
    s_mov_b64 exec, -1
    v_cvt_pk_bf16_f32 v100, v56, v57
    v_cvt_pk_bf16_f32 v101, v58, v59
    v_cvt_pk_bf16_f32 v102, v60, v61
    v_cvt_pk_bf16_f32 v103, v62, v63
    s_cmp_eq_u32 s72, 2
    s_nop 0
    v_mfma_f32_32x32x16_bf16 v[80:95], v[108:111], v[100:103], v[80:95]
    s_cbranch_scc1 L_at_p2done
    s_setprio 0
    v_exp_f32 v64, v64
    v_exp_f32 v65, v65
    v_exp_f32 v66, v66
    v_exp_f32 v67, v67
    v_mfma_f32_32x32x16_bf16 v[48:63], v[36:39], v[32:35], v[192:207]
    v_exp_f32 v68, v68
    v_exp_f32 v69, v69
    v_exp_f32 v70, v70
    v_exp_f32 v71, v71
    v_cvt_pk_bf16_f32 v96, v64, v65
    v_cvt_pk_bf16_f32 v97, v66, v67
    v_cvt_pk_bf16_f32 v98, v68, v69
    v_cvt_pk_bf16_f32 v99, v70, v71
    s_waitcnt lgkmcnt(0)
    v_exp_f32 v72, v72
    v_mfma_f32_32x32x16_bf16 v[80:95], v[112:115], v[96:99], v[80:95]
    v_exp_f32 v73, v73
    v_exp_f32 v74, v74
    v_exp_f32 v75, v75
    v_exp_f32 v76, v76
    v_exp_f32 v77, v77
    v_exp_f32 v78, v78
    v_exp_f32 v79, v79
    s_mov_b64 exec, s[68:69]
    ds_read_b128 v[104:107], v209 offset:0
    ds_read_b128 v[108:111], v209 offset:512
    s_mov_b64 exec, -1
    v_cvt_pk_bf16_f32 v100, v72, v73
    v_cvt_pk_bf16_f32 v101, v74, v75
    v_cvt_pk_bf16_f32 v102, v76, v77
    v_cvt_pk_bf16_f32 v103, v78, v79
    s_cmp_eq_u32 s72, 1
    s_nop 0
    v_mfma_f32_32x32x16_bf16 v[80:95], v[116:119], v[100:103], v[80:95]
    s_cbranch_scc1 L_at_p2done
    v_exp_f32 v48, v48
    v_exp_f32 v49, v49
    v_exp_f32 v50, v50
    v_exp_f32 v51, v51
    v_exp_f32 v52, v52
    v_exp_f32 v53, v53
    v_exp_f32 v54, v54
    v_exp_f32 v55, v55
    v_cvt_pk_bf16_f32 v96, v48, v49
    v_cvt_pk_bf16_f32 v97, v50, v51
    v_cvt_pk_bf16_f32 v98, v52, v53
    v_cvt_pk_bf16_f32 v99, v54, v55
    s_waitcnt lgkmcnt(0)
    v_exp_f32 v56, v56
    v_mfma_f32_32x32x16_bf16 v[80:95], v[104:107], v[96:99], v[80:95]
    v_exp_f32 v57, v57
    v_exp_f32 v58, v58
    v_exp_f32 v59, v59
    v_exp_f32 v60, v60
    v_exp_f32 v61, v61
    v_exp_f32 v62, v62
    v_exp_f32 v63, v63
    v_cvt_pk_bf16_f32 v100, v56, v57
    v_cvt_pk_bf16_f32 v101, v58, v59
    v_cvt_pk_bf16_f32 v102, v60, v61
    v_cvt_pk_bf16_f32 v103, v62, v63
    s_nop 1
    v_mfma_f32_32x32x16_bf16 v[80:95], v[108:111], v[100:103], v[80:95]
L_at_p2done:
    s_setprio 0
    s_waitcnt lgkmcnt(0)
    s_nop 11
    v_rcp_f32 v121, v88
    s_nop 0
    v_mul_f32 v80, v80, v121
    v_mul_f32 v81, v81, v121
    v_mul_f32 v82, v82, v121
    v_mul_f32 v83, v83, v121
    v_mul_f32 v84, v84, v121
    v_mul_f32 v85, v85, v121
    v_mul_f32 v86, v86, v121
    v_mul_f32 v87, v87, v121
    v_cvt_pk_bf16_f32 v96, v80, v81
    v_cvt_pk_bf16_f32 v97, v82, v83
    v_cvt_pk_bf16_f32 v98, v84, v85
    v_cvt_pk_bf16_f32 v99, v86, v87
    s_nop 0
    s_cmp_eq_u32 s41, 0
    s_cbranch_scc1 a_ds517_s
    buffer_store_dwordx4 v[96:99], v1, s[24:27], s73 offen nt
    s_branch a_ds517_e
a_ds517_s:
    buffer_store_dwordx4 v[96:99], v1, s[24:27], s73 offen sc1
a_ds517_e:
    s_waitcnt vmcnt(0) lgkmcnt(0)
    s_cmp_ge_u32 s38, 4
    s_cbranch_scc1 L_l_postattn
    s_branch L_c_postattn
L_exit:
    s_endpgm
.section .rodata,"a"
.p2align 6
.amdhsa_kernel interleave_layers__sliding_block__mixer_channel_mlp__prompt_kernel
  .amdhsa_next_free_vgpr 256
  .amdhsa_next_free_sgpr 102
  .amdhsa_accum_offset 256
  .amdhsa_group_segment_fixed_size 0
  .amdhsa_kernarg_size 88
  .amdhsa_user_sgpr_count 2
  .amdhsa_user_sgpr_kernarg_segment_ptr 1
  .amdhsa_system_sgpr_workgroup_id_x 1
.end_amdhsa_kernel
```
